```python
import torch

def _softmax(x, axis=-1):
    return torch.softmax(x, dim=axis)

def _gelu(x):
    return torch.nn.functional.gelu(x, approximate='tanh')

def _silu(x):
    return torch.nn.functional.silu(x)

def _sigmoid(x):
    return torch.sigmoid(x)

def _layernorm(x, axis=-1, eps=1e-05):
    m = x.mean(dim=axis, keepdim=True)
    v = x.var(dim=axis, keepdim=True, unbiased=False)
    return (x - m) / torch.sqrt(v + eps)

def _scatter_add(tgt, idx, src, axis=0):
    return tgt.clone().index_add_(axis, idx, src)

def _segment_sum(src, seg, n):
    out = torch.zeros((n,) + src.shape[1:], dtype=src.dtype)
    return out.index_add_(0, seg, src)

def _pad(x, pw):
    flat = tuple((v for pair in reversed(pw) for v in pair))
    return torch.nn.functional.pad(x, flat)
kernel_name = 'adaLN_cond__sliding_block_cached__glu_gated_glu__decode'

def setup_inputs():

    _w = lambda a: (lambda t: t.to(torch.bfloat16) if t.is_floating_point() else t)(torch.as_tensor(a))

    def _A_setup():
        B, Sq, D = (8, 1, 512)
        Hq, Hkv, Sk, Dh = (32, 32, 4096, 128)
        assert Hq % Hkv == 0, (Hq, Hkv)
        return {'x': _w((lambda *s: torch.randn(*s, dtype=torch.bfloat16) * 0.05)(B, Sq, D)), 'k_cache': _w((lambda *s: torch.randn(*s, dtype=torch.bfloat16) * 3.2)(B, Hkv, Sk, Dh)), 'v_cache': _w((lambda *s: torch.randn(*s, dtype=torch.bfloat16) * 0.4)(B, Hkv, Sk, Dh)), 'wq': _w((lambda *s: torch.randn(*s, dtype=torch.bfloat16) * 3.2)(D, Hq * Dh) * D ** (-0.5)), 'wo': _w((lambda *s: torch.randn(*s, dtype=torch.bfloat16) * 0.4)(Hq * Dh, D) * (Hq * Dh) ** (-0.5))}
    _A_in = _A_setup()

    def _B_setup():
        B, S, D, F = (8, 1, 512, 1376)
        return {'x': _w((lambda *s: torch.randn(*s, dtype=torch.bfloat16) * 0.05)(B, S, D)), 'w_gate': _w((lambda *s: torch.randn(*s, dtype=torch.bfloat16) * 0.05)(D, F)), 'w_up': _w((lambda *s: torch.randn(*s, dtype=torch.bfloat16) * 0.05)(D, F)), 'w_down': _w((lambda *s: torch.randn(*s, dtype=torch.bfloat16) * 0.05)(F, D))}
    _B_in = _B_setup()
    return {'A_x': _A_in['x'], 'A_k_cache': _A_in['k_cache'], 'A_v_cache': _A_in['v_cache'], 'A_wq': _A_in['wq'], 'A_wo': _A_in['wo'], 'B_x': _B_in['x'], 'B_w_gate': _B_in['w_gate'], 'B_w_up': _B_in['w_up'], 'B_w_down': _B_in['w_down'], 'c': _w((lambda *s: torch.randn(*s, dtype=torch.bfloat16) * 0.1)(8, 512) * 8.0), 'w_mod': _w((lambda *s: torch.randn(*s, dtype=torch.bfloat16) * 0.1)(512, 6 * 512) * 512 ** (-0.5) * 8.0)}

def reference(A_x, A_k_cache, A_v_cache, A_wq, A_wo, B_x, B_w_gate, B_w_up, B_w_down, c, w_mod):

    def _A_ref(x, k_cache, v_cache, wq, wo):
        B, Sq, D = x.shape
        Hq, Dh = (32, 128)
        Hkv, Sk = (k_cache.shape[1], k_cache.shape[2])
        W = min(4096, max(256, Sk // 4))
        rep = Hq // Hkv
        q = (lambda x, *d: x.permute(*d))((x @ wq).reshape(B, Sq, Hq, Dh), 0, 2, 1, 3)
        k = (lambda x, n, axis: torch.repeat_interleave(x, n, dim=axis))(k_cache[:, :, Sk - W:, :], rep, axis=1)
        v = (lambda x, n, axis: torch.repeat_interleave(x, n, dim=axis))(v_cache[:, :, Sk - W:, :], rep, axis=1)
        scores = torch.einsum('bhqd,bhkd->bhqk', q, k) * Dh ** (-0.5)
        p = _softmax(scores, axis=-1)
        o = torch.einsum('bhqk,bhkd->bhqd', p, v)
        return (lambda x, *d: x.permute(*d))(o, 0, 2, 1, 3).reshape(B, Sq, Hq * Dh) @ wo

    def _B_ref(x, w_gate, w_up, w_down):
        g = torch.einsum('bsd,df->bsf', x, w_gate)
        u = torch.einsum('bsd,df->bsf', x, w_up)
        h = _sigmoid(g) * u
        return torch.einsum('bsf,fd->bsd', h, w_down)
    x = A_x
    mod = (_silu(c) @ w_mod).reshape(c.shape[0], 6, 1, -1)
    sa, ca, ga, sb, cb, gb = (mod[:, 0].clone(), mod[:, 1].clone(), mod[:, 2].clone(), mod[:, 3].clone(), mod[:, 4].clone(), mod[:, 5].clone())
    h = _layernorm(x, axis=-1) * (1 + ca) + sa
    x = x + ga * _A_ref(h, A_k_cache, A_v_cache, A_wq, A_wo)
    h = _layernorm(x, axis=-1) * (1 + cb) + sb
    x = x + gb * _B_ref(h, B_w_gate, B_w_up, B_w_down)
    return x
```

```asm
; @launch grid=(256,1,1) block=(768,1,1) lds=159744
.amdgcn_target "amdgcn-amd-amdhsa--gfx950"
.text
.globl adaLN_cond__sliding_block_cached__glu_gated_glu__decode_kernel
.p2align 8
.type adaLN_cond__sliding_block_cached__glu_gated_glu__decode_kernel,@function
adaLN_cond__sliding_block_cached__glu_gated_glu__decode_kernel:
  s_cmp_ge_u32 s2, 256
  s_cbranch_scc1 L_end
  s_load_dwordx16 s[4:19], s[0:1], 0
  s_load_dwordx8 s[20:27], s[0:1], 64
  s_load_dwordx4 s[28:31], s[0:1], 96
  v_lshrrev_b32 v2, 6, v0
  v_and_b32 v0, 63, v0
  v_readfirstlane_b32 s32, v2
  s_nop 0
  s_cmp_ge_u32 s32, 8
  s_cbranch_scc1 L_helper0
  v_lshlrev_b32 v1, 4, v0
  s_and_b32 s33, s2, 7
  s_lshr_b32 s34, s2, 3
  s_lshr_b32 s35, s34, 2
  s_and_b32 s36, s34, 3
  s_lshl_b32 s37, s33, 2
  s_add_u32 s37, s37, s36
  s_cmp_ge_u32 s32, 8
  s_cbranch_scc1 L_nofast_1
  s_lshl_b32 s56, s35, 5
  s_add_u32 s56, s56, s37
  s_lshl_b32 s56, s56, 20
  s_add_u32 s56, s56, 0xC0000
  s_lshl_b32 s40, s32, 12
  s_mov_b32 s50, 0x40000
  s_mov_b32 s51, 0x20000
  s_waitcnt lgkmcnt(0)
  s_add_u32 s48, s6, s56
  s_addc_u32 s49, s7, 0
  buffer_load_dwordx4 v[40:43], v1, s[48:51], s40 offen offset:0 nt
  buffer_load_dwordx4 v[44:47], v1, s[48:51], s40 offen offset:1024 nt
  s_cmp_eq_u32 s36, 1
  s_cselect_b32 s60, s35, 0
  s_cmp_ge_u32 s60, 2
  s_cbranch_scc1 L_nofast_1
  buffer_load_dwordx4 v[48:51], v1, s[48:51], s40 offen offset:2048 nt
  buffer_load_dwordx4 v[52:55], v1, s[48:51], s40 offen offset:3072 nt
L_nofast_1:
  v_mov_b32 v36, 0
  v_mov_b32 v37, 0
  v_lshrrev_b32 v2, 4, v0
  v_and_b32 v3, 15, v0
  v_mov_b32 v38, 0
  v_mov_b32 v39, 1
  s_add_u32 s60, s33, 256
  s_cmp_eq_u32 s34, 28
  s_cselect_b32 s57, s60, 100
  s_sub_u32 s60, s35, 2
  s_lshl_b32 s60, s60, 3
  s_add_u32 s60, s60, s33
  s_cmp_lt_u32 s35, 2
  s_cselect_b32 s60, 64, s60
  s_cmp_eq_u32 s36, 1
  s_cselect_b32 s57, s60, s57
  s_add_u32 s41, s40, 32768
  s_add_u32 s42, s40, 65536
  s_add_u32 s43, s40, 98304
  s_cmp_ge_u32 s57, 48
  s_cbranch_scc1 L_noprod_2
  s_mov_b32 s64, 0
  s_mov_b32 s62, 0x05040100
  s_mov_b32 s63, 0x07060302
  s_mov_b32 s66, 0x3fb8aa3b
  v_and_b32 v4, 7, v3
  v_lshrrev_b32 v5, 3, v3
  v_lshlrev_b32 v6, 10, v4
  v_lshl_add_u32 v6, v5, 6, v6
  v_lshl_add_u32 v6, v2, 4, v6
  s_lshl_b32 s60, s32, 7
  v_add_u32 v6, s60, v6
  global_load_dwordx4 v[8:11], v6, s[22:23]
  v_lshlrev_b32 v7, 5, v5
  v_lshl_add_u32 v7, v2, 3, v7
  v_mul_u32_u24 v7, 6144, v7
  v_lshl_add_u32 v7, v4, 4, v7
  s_mul_i32 s60, s32, 393216
  s_lshl_b32 s61, s57, 7
  s_add_u32 s60, s60, s61
  v_add_u32 v7, s60, v7
  global_load_dwordx4 v[136:139], v7, s[24:25] nt
  v_add_u32 v7, 6144, v7
  global_load_dwordx4 v[140:143], v7, s[24:25] nt
  v_add_u32 v7, 6144, v7
  global_load_dwordx4 v[144:147], v7, s[24:25] nt
  v_add_u32 v7, 6144, v7
  global_load_dwordx4 v[148:151], v7, s[24:25] nt
  v_add_u32 v7, 6144, v7
  global_load_dwordx4 v[152:155], v7, s[24:25] nt
  v_add_u32 v7, 6144, v7
  global_load_dwordx4 v[156:159], v7, s[24:25] nt
  v_add_u32 v7, 6144, v7
  global_load_dwordx4 v[160:163], v7, s[24:25] nt
  v_add_u32 v7, 6144, v7
  global_load_dwordx4 v[164:167], v7, s[24:25] nt
  s_barrier
  s_lshl_b32 s60, s32, 12
  s_add_u32 s60, s60, 28672
  v_lshlrev_b32 v28, 11, v5
  v_lshl_add_u32 v28, v4, 8, v28
  v_and_b32 v29, 1, v2
  v_lshl_add_u32 v28, v29, 4, v28
  v_add_u32 v28, s60, v28
  v_lshrrev_b32 v29, 1, v2
  v_cmp_eq_u32 s[68:69], v29, v5
  s_waitcnt vmcnt(8)
  v_lshlrev_b32 v16, 16, v8
  v_and_b32 v17, 0xffff0000, v8
  v_max_f32 v20, 0xc2ae0000, v16
  v_max_f32 v21, 0xc2ae0000, v17
  v_mul_f32 v18, s66, v20
  v_mul_f32 v19, s66, v21
  v_fma_f32 v22, v20, s66, -v18
  v_fma_f32 v23, v21, s66, -v19
  v_exp_f32 v18, -v18
  v_exp_f32 v19, -v19
  v_fmac_f32 v22, 0x32a57060, v20
  v_fmac_f32 v23, 0x32a57060, v21
  v_mul_f32 v22, 0xbf317218, v22
  v_mul_f32 v23, 0xbf317218, v23
  v_fmac_f32 v18, v18, v22
  v_fmac_f32 v19, v19, v23
  v_add_f32 v18, 1.0, v18
  v_add_f32 v19, 1.0, v19
  v_rcp_f32 v20, v18
  v_rcp_f32 v21, v19
  v_fma_f32 v22, -v18, v20, 1.0
  v_fma_f32 v23, -v19, v21, 1.0
  v_fmac_f32 v20, v22, v20
  v_fmac_f32 v21, v23, v21
  v_mul_f32 v24, v16, v20
  v_mul_f32 v25, v17, v21
  v_fma_f32 v22, -v24, v18, v16
  v_fma_f32 v23, -v25, v19, v17
  v_fmac_f32 v24, v22, v20
  v_fmac_f32 v25, v23, v21
  v_cvt_pk_bf16_f32 v8, v24, v25
  v_lshlrev_b32 v16, 16, v9
  v_and_b32 v17, 0xffff0000, v9
  v_max_f32 v20, 0xc2ae0000, v16
  v_max_f32 v21, 0xc2ae0000, v17
  v_mul_f32 v18, s66, v20
  v_mul_f32 v19, s66, v21
  v_fma_f32 v22, v20, s66, -v18
  v_fma_f32 v23, v21, s66, -v19
  v_exp_f32 v18, -v18
  v_exp_f32 v19, -v19
  v_fmac_f32 v22, 0x32a57060, v20
  v_fmac_f32 v23, 0x32a57060, v21
  v_mul_f32 v22, 0xbf317218, v22
  v_mul_f32 v23, 0xbf317218, v23
  v_fmac_f32 v18, v18, v22
  v_fmac_f32 v19, v19, v23
  v_add_f32 v18, 1.0, v18
  v_add_f32 v19, 1.0, v19
  v_rcp_f32 v20, v18
  v_rcp_f32 v21, v19
  v_fma_f32 v22, -v18, v20, 1.0
  v_fma_f32 v23, -v19, v21, 1.0
  v_fmac_f32 v20, v22, v20
  v_fmac_f32 v21, v23, v21
  v_mul_f32 v24, v16, v20
  v_mul_f32 v25, v17, v21
  v_fma_f32 v22, -v24, v18, v16
  v_fma_f32 v23, -v25, v19, v17
  v_fmac_f32 v24, v22, v20
  v_fmac_f32 v25, v23, v21
  v_cvt_pk_bf16_f32 v9, v24, v25
  v_lshlrev_b32 v16, 16, v10
  v_and_b32 v17, 0xffff0000, v10
  v_max_f32 v20, 0xc2ae0000, v16
  v_max_f32 v21, 0xc2ae0000, v17
  v_mul_f32 v18, s66, v20
  v_mul_f32 v19, s66, v21
  v_fma_f32 v22, v20, s66, -v18
  v_fma_f32 v23, v21, s66, -v19
  v_exp_f32 v18, -v18
  v_exp_f32 v19, -v19
  v_fmac_f32 v22, 0x32a57060, v20
  v_fmac_f32 v23, 0x32a57060, v21
  v_mul_f32 v22, 0xbf317218, v22
  v_mul_f32 v23, 0xbf317218, v23
  v_fmac_f32 v18, v18, v22
  v_fmac_f32 v19, v19, v23
  v_add_f32 v18, 1.0, v18
  v_add_f32 v19, 1.0, v19
  v_rcp_f32 v20, v18
  v_rcp_f32 v21, v19
  v_fma_f32 v22, -v18, v20, 1.0
  v_fma_f32 v23, -v19, v21, 1.0
  v_fmac_f32 v20, v22, v20
  v_fmac_f32 v21, v23, v21
  v_mul_f32 v24, v16, v20
  v_mul_f32 v25, v17, v21
  v_fma_f32 v22, -v24, v18, v16
  v_fma_f32 v23, -v25, v19, v17
  v_fmac_f32 v24, v22, v20
  v_fmac_f32 v25, v23, v21
  v_cvt_pk_bf16_f32 v10, v24, v25
  v_lshlrev_b32 v16, 16, v11
  v_and_b32 v17, 0xffff0000, v11
  v_max_f32 v20, 0xc2ae0000, v16
  v_max_f32 v21, 0xc2ae0000, v17
  v_mul_f32 v18, s66, v20
  v_mul_f32 v19, s66, v21
  v_fma_f32 v22, v20, s66, -v18
  v_fma_f32 v23, v21, s66, -v19
  v_exp_f32 v18, -v18
  v_exp_f32 v19, -v19
  v_fmac_f32 v22, 0x32a57060, v20
  v_fmac_f32 v23, 0x32a57060, v21
  v_mul_f32 v22, 0xbf317218, v22
  v_mul_f32 v23, 0xbf317218, v23
  v_fmac_f32 v18, v18, v22
  v_fmac_f32 v19, v19, v23
  v_add_f32 v18, 1.0, v18
  v_add_f32 v19, 1.0, v19
  v_rcp_f32 v20, v18
  v_rcp_f32 v21, v19
  v_fma_f32 v22, -v18, v20, 1.0
  v_fma_f32 v23, -v19, v21, 1.0
  v_fmac_f32 v20, v22, v20
  v_fmac_f32 v21, v23, v21
  v_mul_f32 v24, v16, v20
  v_mul_f32 v25, v17, v21
  v_fma_f32 v22, -v24, v18, v16
  v_fma_f32 v23, -v25, v19, v17
  v_fmac_f32 v24, v22, v20
  v_fmac_f32 v25, v23, v21
  v_cvt_pk_bf16_f32 v11, v24, v25
  s_load_dword s3, s[28:29], 0x80
  s_waitcnt vmcnt(3)
  buffer_load_dwordx4 v[48:51], v1, s[48:51], s40 offen offset:2048 nt
  s_waitcnt vmcnt(3)
  buffer_load_dwordx4 v[52:55], v1, s[48:51], s40 offen offset:3072 nt
  s_waitcnt vmcnt(3)
  buffer_load_dwordx4 v[56:59], v1, s[48:51], s41 offen offset:0 nt
  s_waitcnt vmcnt(3)
  buffer_load_dwordx4 v[60:63], v1, s[48:51], s41 offen offset:1024 nt
  v_perm_b32 v5, v140, v136, s62
  v_perm_b32 v140, v140, v136, s63
  v_mov_b32 v136, v5
  v_perm_b32 v5, v141, v137, s62
  v_perm_b32 v6, v141, v137, s63
  v_perm_b32 v137, v148, v144, s62
  v_perm_b32 v141, v148, v144, s63
  v_mov_b32 v144, v5
  v_mov_b32 v148, v6
  v_perm_b32 v5, v142, v138, s62
  v_perm_b32 v6, v142, v138, s63
  v_perm_b32 v138, v156, v152, s62
  v_perm_b32 v142, v156, v152, s63
  v_mov_b32 v152, v5
  v_mov_b32 v156, v6
  v_perm_b32 v5, v143, v139, s62
  v_perm_b32 v6, v143, v139, s63
  v_perm_b32 v139, v164, v160, s62
  v_perm_b32 v143, v164, v160, s63
  v_mov_b32 v160, v5
  v_mov_b32 v164, v6
  v_perm_b32 v5, v149, v145, s62
  v_perm_b32 v149, v149, v145, s63
  v_mov_b32 v145, v5
  v_perm_b32 v5, v150, v146, s62
  v_perm_b32 v6, v150, v146, s63
  v_perm_b32 v146, v157, v153, s62
  v_perm_b32 v150, v157, v153, s63
  v_mov_b32 v153, v5
  v_mov_b32 v157, v6
  v_perm_b32 v5, v151, v147, s62
  v_perm_b32 v6, v151, v147, s63
  v_perm_b32 v147, v165, v161, s62
  v_perm_b32 v151, v165, v161, s63
  v_mov_b32 v161, v5
  v_mov_b32 v165, v6
  v_perm_b32 v5, v158, v154, s62
  v_perm_b32 v158, v158, v154, s63
  v_mov_b32 v154, v5
  v_perm_b32 v5, v159, v155, s62
  v_perm_b32 v6, v159, v155, s63
  v_perm_b32 v155, v166, v162, s62
  v_perm_b32 v159, v166, v162, s63
  v_mov_b32 v162, v5
  v_mov_b32 v166, v6
  v_perm_b32 v5, v167, v163, s62
  v_perm_b32 v167, v167, v163, s63
  v_mov_b32 v163, v5
  v_mfma_f32_16x16x32_bf16 v[104:107], v[8:11], v[136:139], 0
  v_mfma_f32_16x16x32_bf16 v[108:111], v[8:11], v[140:143], 0
  v_mfma_f32_16x16x32_bf16 v[112:115], v[8:11], v[144:147], 0
  v_mfma_f32_16x16x32_bf16 v[116:119], v[8:11], v[148:151], 0
  v_mfma_f32_16x16x32_bf16 v[120:123], v[8:11], v[152:155], 0
  v_mfma_f32_16x16x32_bf16 v[124:127], v[8:11], v[156:159], 0
  v_mfma_f32_16x16x32_bf16 v[128:131], v[8:11], v[160:163], 0
  v_mfma_f32_16x16x32_bf16 v[132:135], v[8:11], v[164:167], 0
  s_mov_b64 exec, s[68:69]
  ds_write_b128 v28, v[104:107] offset:0
  ds_write_b128 v28, v[108:111] offset:32
  ds_write_b128 v28, v[112:115] offset:64
  ds_write_b128 v28, v[116:119] offset:96
  ds_write_b128 v28, v[120:123] offset:128
  ds_write_b128 v28, v[124:127] offset:160
  ds_write_b128 v28, v[128:131] offset:192
  ds_write_b128 v28, v[132:135] offset:224
  s_mov_b64 exec, 1
  ds_add_u32 v38, v39 offset:20
  s_mov_b64 exec, -1
  s_waitcnt vmcnt(3)
  buffer_load_dwordx4 v[64:67], v1, s[48:51], s41 offen offset:2048 nt
  s_waitcnt vmcnt(3)
  buffer_load_dwordx4 v[68:71], v1, s[48:51], s41 offen offset:3072 nt
  v_and_b32 v4, 31, v0
  v_lshrrev_b32 v5, 5, v0
  v_lshlrev_b32 v6, 6, v4
  v_lshl_add_u32 v6, v5, 14, v6
  s_lshl_b32 s60, s32, 2
  s_add_u32 s60, s60, 28672
  v_add_u32 v6, s60, v6
  s_mul_i32 s60, s32, 6144
  s_lshl_b32 s61, s57, 7
  s_add_u32 s60, s60, s61
  s_add_u32 s60, s60, 0
  v_lshl_add_u32 v5, v4, 2, s60
L_spin_4:
  ds_read_b32 v7, v38 offset:20
  s_waitcnt lgkmcnt(0)
  v_readfirstlane_b32 s60, v7
  s_nop 0
  s_cmp_ge_u32 s60, 8
  s_cbranch_scc1 L_spun_5
  s_add_u32 s64, s64, 1
  s_cmp_gt_u32 s64, 200000
  s_cbranch_scc1 L_exit
  s_sleep 1
  s_branch L_spin_4
L_spun_5:
  ds_read2_b32 v[8:9], v6 offset0:0 offset1:8
  v_add_u32 v6, 2048, v6
  ds_read2_b32 v[10:11], v6 offset0:0 offset1:8
  v_add_u32 v6, 2048, v6
  ds_read2_b32 v[12:13], v6 offset0:0 offset1:8
  v_add_u32 v6, 2048, v6
  ds_read2_b32 v[14:15], v6 offset0:0 offset1:8
  v_add_u32 v6, 2048, v6
  ds_read2_b32 v[16:17], v6 offset0:0 offset1:8
  v_add_u32 v6, 2048, v6
  ds_read2_b32 v[18:19], v6 offset0:0 offset1:8
  v_add_u32 v6, 2048, v6
  ds_read2_b32 v[20:21], v6 offset0:0 offset1:8
  v_add_u32 v6, 2048, v6
  ds_read2_b32 v[22:23], v6 offset0:0 offset1:8
L_pollSN_6:
  s_cmp_lg_u32 s3, 0
  s_cbranch_scc1 L_gotSN_7
  s_add_u32 s64, s64, 1
  s_cmp_gt_u32 s64, 200000
  s_cbranch_scc1 L_exit
  s_load_dword s3, s[28:29], 0x80 glc
  s_waitcnt lgkmcnt(0)
  s_branch L_pollSN_6
L_gotSN_7:
  s_waitcnt lgkmcnt(0)
  s_mov_b64 exec, 1
  ds_add_u32 v38, v39 offset:24
  s_mov_b64 exec, -1
  v_add_f32 v8, v8, v10
  v_add_f32 v9, v9, v11
  v_add_f32 v8, v8, v12
  v_add_f32 v9, v9, v13
  v_add_f32 v8, v8, v14
  v_add_f32 v9, v9, v15
  v_add_f32 v8, v8, v16
  v_add_f32 v9, v9, v17
  v_add_f32 v8, v8, v18
  v_add_f32 v9, v9, v19
  v_add_f32 v8, v8, v20
  v_add_f32 v9, v9, v21
  v_add_f32 v8, v8, v22
  v_add_f32 v9, v9, v23
  v_mov_b32 v10, v8
  v_mov_b32 v11, v9
  s_nop 0
  v_permlane32_swap_b32 v10, v8
  v_permlane32_swap_b32 v11, v9
  v_add_f32 v8, v8, v10
  v_add_f32 v9, v9, v11
  v_cvt_pk_bf16_f32 v8, v8, v9
  s_mov_b32 exec_hi, 0
  global_store_dword v5, v8, s[30:31] sc1
  s_mov_b64 exec, -1
  v_mov_b32 v9, v8
  s_nop 1
  v_xor_b32_dpp v9, v9, v9 quad_perm:[1,0,3,2] row_mask:0xf bank_mask:0xf
  s_nop 1
  v_xor_b32_dpp v9, v9, v9 quad_perm:[2,3,0,1] row_mask:0xf bank_mask:0xf
  s_nop 1
  v_xor_b32_dpp v9, v9, v9 row_ror:4 row_mask:0xf bank_mask:0xf
  s_nop 1
  v_xor_b32_dpp v9, v9, v9 row_ror:8 row_mask:0xf bank_mask:0xf
  v_mov_b32 v10, v9
  s_nop 1
  v_permlane16_swap_b32 v10, v9
  v_bitop3_b32 v9, v9, v10, s3 bitop3:0x96
  s_lshl_b32 s60, s32, 8
  s_lshl_b32 s61, s57, 2
  s_add_u32 s60, s60, s61
  s_add_u32 s60, s60, 53248
  v_mov_b32 v5, s60
  s_mov_b64 exec, 1
  global_store_dword v5, v9, s[30:31] sc1
  s_mov_b64 exec, -1
  s_branch L_joined_3
L_noprod_2:
  s_waitcnt vmcnt(2)
  buffer_load_dwordx4 v[56:59], v1, s[48:51], s41 offen offset:0 nt
  s_barrier
  s_waitcnt vmcnt(2)
  buffer_load_dwordx4 v[60:63], v1, s[48:51], s41 offen offset:1024 nt
  s_waitcnt vmcnt(2)
  buffer_load_dwordx4 v[64:67], v1, s[48:51], s41 offen offset:2048 nt
  s_waitcnt vmcnt(2)
  buffer_load_dwordx4 v[68:71], v1, s[48:51], s41 offen offset:3072 nt
L_joined_3:
  s_mul_i32 s65, s35, 3
  s_add_u32 s65, s65, s36
  s_lshr_b32 s60, s36, 1
  s_sub_u32 s65, s65, s60
  s_lshr_b32 s61, s65, 2
  s_lshr_b32 s60, s33, 1
  s_mul_i32 s38, s33, 5
  s_add_u32 s38, s38, s60
  s_add_u32 s38, s38, s61
  s_sub_u32 s38, s38, 1
  s_and_b32 s60, s33, 1
  s_add_u32 s60, s60, 5
  s_cmp_lt_u32 s61, s60
  s_cselect_b32 s39, 1, 0
  s_cmp_lt_u32 s38, 43
  s_cselect_b32 s39, s39, 0
  s_cmp_eq_u32 s36, 1
  s_cselect_b32 s39, 0, s39
  s_and_b32 s36, s65, 3
  s_mov_b32 s64, 0
  s_mov_b32 s62, 0x05040100
  s_mov_b32 s63, 0x07060302
  s_mov_b32 s66, 0x3fb8aa3b
  s_cmp_lt_u32 s32, 4
  s_cbranch_scc1 L_sp_8
  s_setprio 1
L_sp_8:
  s_lshl_b32 s60, s35, 5
  s_add_u32 s60, s60, s37
  s_lshl_b32 s60, s60, 20
  s_add_u32 s60, s60, 0xC0000
  s_lshl_b32 s40, s32, 12
  s_mul_i32 s56, s32, 16384
  s_add_u32 s56, s56, 28672
  s_add_u32 s41, s40, 32768
  s_add_u32 s42, s40, 65536
  s_add_u32 s43, s40, 98304
  s_add_u32 s44, s40, 131072
  s_add_u32 s45, s40, 163840
  s_add_u32 s46, s40, 196608
  s_add_u32 s47, s40, 229376
  s_mov_b32 s50, 0x40000
  s_mov_b32 s51, 0x20000
  s_mov_b32 s54, 0x40000
  s_mov_b32 s55, 0x20000
  s_waitcnt lgkmcnt(0)
  s_bitcmp1_b32 s33, 0
  s_mov_b32 s58, 0xbf7efbf7
  s_cselect_b32 s58, 0xbf7efbf7, s58
  s_cmp_lt_u32 s57, 48
  s_cselect_b32 s58, 0x0, s58
  s_cmp_eq_u32 s57, 64
  s_cselect_b32 s58, 0xbf7efbf7, s58
  s_bitcmp1_b32 s33, 0
  s_mov_b32 s59, 0x2fbf7ef
  s_cselect_b32 s59, 0x2fbf7ef, s59
  s_cmp_lt_u32 s57, 48
  s_cselect_b32 s59, 0x0, s59
  s_cmp_eq_u32 s57, 64
  s_cselect_b32 s59, 0x294a52b, s59
  s_bitcmp1_b32 s33, 0
  s_mov_b32 s14, 0x0
  s_cselect_b32 s14, 0x0, s14
  s_cmp_lt_u32 s57, 48
  s_cselect_b32 s14, 0x0, s14
  s_cmp_eq_u32 s57, 64
  s_cselect_b32 s14, 0x0, s14
  s_bitcmp1_b32 s33, 0
  s_mov_b32 s15, 0x0
  s_cselect_b32 s15, 0x0, s15
  s_cmp_lt_u32 s57, 48
  s_cselect_b32 s15, 0x0, s15
  s_cmp_eq_u32 s57, 64
  s_cselect_b32 s15, 0x0, s15
  s_waitcnt lgkmcnt(0)
  s_add_u32 s48, s6, s60
  s_addc_u32 s49, s7, 0
  s_add_u32 s52, s8, s60
  s_addc_u32 s53, s9, 0
  s_waitcnt vmcnt(3)
  s_bitcmp1_b64 s[58:59], 8
  s_cbranch_scc0 L_pc_9
  s_waitcnt vmcnt(2)
  s_bitcmp1_b64 s[14:15], 8
  s_cbranch_scc0 L_pc_9
  s_waitcnt vmcnt(1)
L_pc_9:
  buffer_load_dwordx4 v[72:75], v1, s[48:51], s42 offen offset:0 nt
  v_lshrrev_b32 v12, 1, v3
  v_and_b32 v13, 1, v3
  v_mov_b32 v14, 0xffff
  v_lshlrev_b32 v13, 4, v13
  v_lshlrev_b32 v14, v13, v14
  v_cmp_eq_u32 vcc, 0, v12
  s_nop 1
  v_cndmask_b32 v4, 0, v14, vcc
  v_cmp_eq_u32 vcc, 1, v12
  s_nop 1
  v_cndmask_b32 v5, 0, v14, vcc
  v_cmp_eq_u32 vcc, 2, v12
  s_nop 1
  v_cndmask_b32 v6, 0, v14, vcc
  v_cmp_eq_u32 vcc, 3, v12
  s_nop 1
  v_cndmask_b32 v7, 0, v14, vcc
  s_waitcnt vmcnt(3)
  s_bitcmp1_b64 s[58:59], 9
  s_cbranch_scc0 L_pc_10
  s_waitcnt vmcnt(2)
  s_bitcmp1_b64 s[14:15], 9
  s_cbranch_scc0 L_pc_10
  s_waitcnt vmcnt(1)
L_pc_10:
  buffer_load_dwordx4 v[76:79], v1, s[48:51], s42 offen offset:1024 nt
  s_waitcnt vmcnt(3)
  s_bitcmp1_b64 s[58:59], 10
  s_cbranch_scc0 L_pc_11
  s_waitcnt vmcnt(2)
  s_bitcmp1_b64 s[14:15], 10
  s_cbranch_scc0 L_pc_11
  s_waitcnt vmcnt(1)
L_pc_11:
  buffer_load_dwordx4 v[80:83], v1, s[48:51], s42 offen offset:2048 nt
  s_waitcnt vmcnt(3)
  s_bitcmp1_b64 s[58:59], 11
  s_cbranch_scc0 L_pc_12
  s_waitcnt vmcnt(2)
  s_bitcmp1_b64 s[14:15], 11
  s_cbranch_scc0 L_pc_12
  s_waitcnt vmcnt(1)
L_pc_12:
  buffer_load_dwordx4 v[84:87], v1, s[48:51], s42 offen offset:3072 nt
  s_waitcnt vmcnt(3)
  s_bitcmp1_b64 s[58:59], 12
  s_cbranch_scc0 L_pc_13
  s_waitcnt vmcnt(2)
  s_bitcmp1_b64 s[14:15], 12
  s_cbranch_scc0 L_pc_13
  s_waitcnt vmcnt(1)
L_pc_13:
  buffer_load_dwordx4 v[88:91], v1, s[48:51], s43 offen offset:0 nt
  s_waitcnt vmcnt(3)
  s_bitcmp1_b64 s[58:59], 13
  s_cbranch_scc0 L_pc_14
  s_waitcnt vmcnt(2)
  s_bitcmp1_b64 s[14:15], 13
  s_cbranch_scc0 L_pc_14
  s_waitcnt vmcnt(1)
L_pc_14:
  buffer_load_dwordx4 v[92:95], v1, s[48:51], s43 offen offset:1024 nt
  s_waitcnt vmcnt(3)
  s_bitcmp1_b64 s[58:59], 14
  s_cbranch_scc0 L_pc_15
  s_waitcnt vmcnt(2)
  s_bitcmp1_b64 s[14:15], 14
  s_cbranch_scc0 L_pc_15
  s_waitcnt vmcnt(1)
L_pc_15:
  buffer_load_dwordx4 v[96:99], v1, s[48:51], s43 offen offset:2048 nt
  s_waitcnt vmcnt(3)
  s_bitcmp1_b64 s[58:59], 15
  s_cbranch_scc0 L_pc_16
  s_waitcnt vmcnt(2)
  s_bitcmp1_b64 s[14:15], 15
  s_cbranch_scc0 L_pc_16
  s_waitcnt vmcnt(1)
L_pc_16:
  buffer_load_dwordx4 v[100:103], v1, s[48:51], s43 offen offset:3072 nt
  s_waitcnt vmcnt(3)
  s_bitcmp1_b64 s[58:59], 16
  s_cbranch_scc0 L_pc_17
  s_waitcnt vmcnt(2)
  s_bitcmp1_b64 s[14:15], 16
  s_cbranch_scc0 L_pc_17
  s_waitcnt vmcnt(1)
L_pc_17:
  buffer_load_dwordx4 v[104:107], v1, s[48:51], s44 offen offset:0 nt
  s_waitcnt vmcnt(3)
  s_bitcmp1_b64 s[58:59], 17
  s_cbranch_scc0 L_pc_18
  s_waitcnt vmcnt(2)
  s_bitcmp1_b64 s[14:15], 17
  s_cbranch_scc0 L_pc_18
  s_waitcnt vmcnt(1)
L_pc_18:
  buffer_load_dwordx4 v[108:111], v1, s[48:51], s44 offen offset:1024 nt
  s_waitcnt vmcnt(3)
  s_bitcmp1_b64 s[58:59], 18
  s_cbranch_scc0 L_pc_19
  s_waitcnt vmcnt(2)
  s_bitcmp1_b64 s[14:15], 18
  s_cbranch_scc0 L_pc_19
  s_waitcnt vmcnt(1)
L_pc_19:
  buffer_load_dwordx4 v[112:115], v1, s[48:51], s44 offen offset:2048 nt
  s_waitcnt vmcnt(3)
  s_bitcmp1_b64 s[58:59], 19
  s_cbranch_scc0 L_pc_20
  s_waitcnt vmcnt(2)
  s_bitcmp1_b64 s[14:15], 19
  s_cbranch_scc0 L_pc_20
  s_waitcnt vmcnt(1)
L_pc_20:
  buffer_load_dwordx4 v[116:119], v1, s[48:51], s44 offen offset:3072 nt
  s_waitcnt vmcnt(3)
  s_bitcmp1_b64 s[58:59], 20
  s_cbranch_scc0 L_pc_21
  s_waitcnt vmcnt(2)
  s_bitcmp1_b64 s[14:15], 20
  s_cbranch_scc0 L_pc_21
  s_waitcnt vmcnt(1)
L_pc_21:
  buffer_load_dwordx4 v[120:123], v1, s[48:51], s45 offen offset:0 nt
  s_waitcnt vmcnt(3)
  s_bitcmp1_b64 s[58:59], 21
  s_cbranch_scc0 L_pc_22
  s_waitcnt vmcnt(2)
  s_bitcmp1_b64 s[14:15], 21
  s_cbranch_scc0 L_pc_22
  s_waitcnt vmcnt(1)
L_pc_22:
  buffer_load_dwordx4 v[124:127], v1, s[48:51], s45 offen offset:1024 nt
  s_waitcnt vmcnt(3)
  s_bitcmp1_b64 s[58:59], 22
  s_cbranch_scc0 L_pc_23
  s_waitcnt vmcnt(2)
  s_bitcmp1_b64 s[14:15], 22
  s_cbranch_scc0 L_pc_23
  s_waitcnt vmcnt(1)
L_pc_23:
  buffer_load_dwordx4 v[128:131], v1, s[48:51], s45 offen offset:2048 nt
  s_waitcnt vmcnt(3)
  s_bitcmp1_b64 s[58:59], 23
  s_cbranch_scc0 L_pc_24
  s_waitcnt vmcnt(2)
  s_bitcmp1_b64 s[14:15], 23
  s_cbranch_scc0 L_pc_24
  s_waitcnt vmcnt(1)
L_pc_24:
  buffer_load_dwordx4 v[132:135], v1, s[48:51], s45 offen offset:3072 nt
  s_waitcnt vmcnt(3)
  s_bitcmp1_b64 s[58:59], 24
  s_cbranch_scc0 L_pc_25
  s_waitcnt vmcnt(2)
  s_bitcmp1_b64 s[14:15], 24
  s_cbranch_scc0 L_pc_25
  s_waitcnt vmcnt(1)
L_pc_25:
  buffer_load_dwordx4 v[136:139], v1, s[48:51], s46 offen offset:0 nt
  s_waitcnt vmcnt(3)
  s_bitcmp1_b64 s[58:59], 25
  s_cbranch_scc0 L_pc_26
  s_waitcnt vmcnt(2)
  s_bitcmp1_b64 s[14:15], 25
  s_cbranch_scc0 L_pc_26
  s_waitcnt vmcnt(1)
L_pc_26:
  buffer_load_dwordx4 v[140:143], v1, s[48:51], s46 offen offset:1024 nt
  s_waitcnt vmcnt(3)
  s_bitcmp1_b64 s[58:59], 26
  s_cbranch_scc0 L_pc_27
  s_waitcnt vmcnt(2)
  s_bitcmp1_b64 s[14:15], 26
  s_cbranch_scc0 L_pc_27
  s_waitcnt vmcnt(1)
L_pc_27:
  buffer_load_dwordx4 v[144:147], v1, s[48:51], s46 offen offset:2048 nt
  s_waitcnt vmcnt(3)
  s_bitcmp1_b64 s[58:59], 27
  s_cbranch_scc0 L_pc_28
  s_waitcnt vmcnt(2)
  s_bitcmp1_b64 s[14:15], 27
  s_cbranch_scc0 L_pc_28
  s_waitcnt vmcnt(1)
L_pc_28:
  buffer_load_dwordx4 v[148:151], v1, s[48:51], s46 offen offset:3072 nt
  s_waitcnt vmcnt(3)
  s_bitcmp1_b64 s[58:59], 28
  s_cbranch_scc0 L_pc_29
  s_waitcnt vmcnt(2)
  s_bitcmp1_b64 s[14:15], 28
  s_cbranch_scc0 L_pc_29
  s_waitcnt vmcnt(1)
L_pc_29:
  buffer_load_dwordx4 v[152:155], v1, s[48:51], s47 offen offset:0 nt
  s_waitcnt vmcnt(3)
  s_bitcmp1_b64 s[58:59], 29
  s_cbranch_scc0 L_pc_30
  s_waitcnt vmcnt(2)
  s_bitcmp1_b64 s[14:15], 29
  s_cbranch_scc0 L_pc_30
  s_waitcnt vmcnt(1)
L_pc_30:
  buffer_load_dwordx4 v[156:159], v1, s[48:51], s47 offen offset:1024 nt
  s_waitcnt vmcnt(3)
  s_bitcmp1_b64 s[58:59], 30
  s_cbranch_scc0 L_pc_31
  s_waitcnt vmcnt(2)
  s_bitcmp1_b64 s[14:15], 30
  s_cbranch_scc0 L_pc_31
  s_waitcnt vmcnt(1)
L_pc_31:
  buffer_load_dwordx4 v[160:163], v1, s[48:51], s47 offen offset:2048 nt
  s_waitcnt vmcnt(3)
  s_bitcmp1_b64 s[58:59], 31
  s_cbranch_scc0 L_pc_32
  s_waitcnt vmcnt(2)
  s_bitcmp1_b64 s[14:15], 31
  s_cbranch_scc0 L_pc_32
  s_waitcnt vmcnt(1)
L_pc_32:
  buffer_load_dwordx4 v[164:167], v1, s[48:51], s47 offen offset:3072 nt
  s_setprio 0
  s_cmp_ge_u32 s57, 48
  s_cbranch_scc1 L_nomodchk_33
L_spin_34:
  ds_read_b32 v12, v38 offset:24
  s_waitcnt lgkmcnt(0)
  v_readfirstlane_b32 s60, v12
  s_nop 0
  s_cmp_ge_u32 s60, 8
  s_cbranch_scc1 L_spun_35
  s_add_u32 s64, s64, 1
  s_cmp_gt_u32 s64, 200000
  s_cbranch_scc1 L_exit
  s_sleep 1
  s_branch L_spin_34
L_spun_35:
L_nomodchk_33:
  s_add_u32 m0, s56, 0
  s_waitcnt vmcnt(3)
  s_bitcmp1_b64 s[58:59], 32
  s_cbranch_scc0 L_pc_36
  s_waitcnt vmcnt(2)
  s_bitcmp1_b64 s[14:15], 32
  s_cbranch_scc0 L_pc_36
  s_waitcnt vmcnt(1)
L_pc_36:
  buffer_load_dwordx4 v1, s[52:55], s40 offen offset:0 nt lds
  s_waitcnt vmcnt(3)
  s_bitcmp1_b64 s[58:59], 33
  s_cbranch_scc0 L_pc_37
  s_waitcnt vmcnt(2)
  s_bitcmp1_b64 s[14:15], 33
  s_cbranch_scc0 L_pc_37
  s_waitcnt vmcnt(1)
L_pc_37:
  buffer_load_dwordx4 v1, s[52:55], s40 offen offset:1024 nt lds
  s_waitcnt vmcnt(3)
  s_bitcmp1_b64 s[58:59], 34
  s_cbranch_scc0 L_pc_38
  s_waitcnt vmcnt(2)
  s_bitcmp1_b64 s[14:15], 34
  s_cbranch_scc0 L_pc_38
  s_waitcnt vmcnt(1)
L_pc_38:
  buffer_load_dwordx4 v1, s[52:55], s40 offen offset:2048 nt lds
  s_waitcnt vmcnt(3)
  s_bitcmp1_b64 s[58:59], 35
  s_cbranch_scc0 L_pc_39
  s_waitcnt vmcnt(2)
  s_bitcmp1_b64 s[14:15], 35
  s_cbranch_scc0 L_pc_39
  s_waitcnt vmcnt(1)
L_pc_39:
  buffer_load_dwordx4 v1, s[52:55], s40 offen offset:3072 nt lds
  s_add_u32 m0, s56, 4096
  s_waitcnt vmcnt(3)
  s_bitcmp1_b64 s[58:59], 36
  s_cbranch_scc0 L_pc_40
  s_waitcnt vmcnt(2)
  s_bitcmp1_b64 s[14:15], 36
  s_cbranch_scc0 L_pc_40
  s_waitcnt vmcnt(1)
L_pc_40:
  buffer_load_dwordx4 v1, s[52:55], s41 offen offset:0 nt lds
  s_waitcnt vmcnt(3)
  s_bitcmp1_b64 s[58:59], 37
  s_cbranch_scc0 L_pc_41
  s_waitcnt vmcnt(2)
  s_bitcmp1_b64 s[14:15], 37
  s_cbranch_scc0 L_pc_41
  s_waitcnt vmcnt(1)
L_pc_41:
  buffer_load_dwordx4 v1, s[52:55], s41 offen offset:1024 nt lds
  s_waitcnt vmcnt(3)
  s_bitcmp1_b64 s[58:59], 38
  s_cbranch_scc0 L_pc_42
  s_waitcnt vmcnt(2)
  s_bitcmp1_b64 s[14:15], 38
  s_cbranch_scc0 L_pc_42
  s_waitcnt vmcnt(1)
L_pc_42:
  buffer_load_dwordx4 v1, s[52:55], s41 offen offset:2048 nt lds
  s_waitcnt vmcnt(3)
  s_bitcmp1_b64 s[58:59], 39
  s_cbranch_scc0 L_pc_43
  s_waitcnt vmcnt(2)
  s_bitcmp1_b64 s[14:15], 39
  s_cbranch_scc0 L_pc_43
  s_waitcnt vmcnt(1)
L_pc_43:
  buffer_load_dwordx4 v1, s[52:55], s41 offen offset:3072 nt lds
  s_add_u32 m0, s56, 8192
  s_waitcnt vmcnt(3)
  s_bitcmp1_b64 s[58:59], 40
  s_cbranch_scc0 L_pc_44
  s_waitcnt vmcnt(2)
  s_bitcmp1_b64 s[14:15], 40
  s_cbranch_scc0 L_pc_44
  s_waitcnt vmcnt(1)
L_pc_44:
  buffer_load_dwordx4 v1, s[52:55], s42 offen offset:0 nt lds
  s_waitcnt vmcnt(3)
  s_bitcmp1_b64 s[58:59], 41
  s_cbranch_scc0 L_pc_45
  s_waitcnt vmcnt(2)
  s_bitcmp1_b64 s[14:15], 41
  s_cbranch_scc0 L_pc_45
  s_waitcnt vmcnt(1)
L_pc_45:
  buffer_load_dwordx4 v1, s[52:55], s42 offen offset:1024 nt lds
  s_waitcnt vmcnt(3)
  s_bitcmp1_b64 s[58:59], 42
  s_cbranch_scc0 L_pc_46
  s_waitcnt vmcnt(2)
  s_bitcmp1_b64 s[14:15], 42
  s_cbranch_scc0 L_pc_46
  s_waitcnt vmcnt(1)
L_pc_46:
  buffer_load_dwordx4 v1, s[52:55], s42 offen offset:2048 nt lds
  s_waitcnt vmcnt(3)
  s_bitcmp1_b64 s[58:59], 43
  s_cbranch_scc0 L_pc_47
  s_waitcnt vmcnt(2)
  s_bitcmp1_b64 s[14:15], 43
  s_cbranch_scc0 L_pc_47
  s_waitcnt vmcnt(1)
L_pc_47:
  buffer_load_dwordx4 v1, s[52:55], s42 offen offset:3072 nt lds
  s_add_u32 m0, s56, 12288
  s_waitcnt vmcnt(3)
  s_bitcmp1_b64 s[58:59], 44
  s_cbranch_scc0 L_pc_48
  s_waitcnt vmcnt(2)
  s_bitcmp1_b64 s[14:15], 44
  s_cbranch_scc0 L_pc_48
  s_waitcnt vmcnt(1)
L_pc_48:
  buffer_load_dwordx4 v1, s[52:55], s43 offen offset:0 nt lds
  s_waitcnt vmcnt(3)
  s_bitcmp1_b64 s[58:59], 45
  s_cbranch_scc0 L_pc_49
  s_waitcnt vmcnt(2)
  s_bitcmp1_b64 s[14:15], 45
  s_cbranch_scc0 L_pc_49
  s_waitcnt vmcnt(1)
L_pc_49:
  buffer_load_dwordx4 v1, s[52:55], s43 offen offset:1024 nt lds
  s_waitcnt vmcnt(3)
  s_bitcmp1_b64 s[58:59], 46
  s_cbranch_scc0 L_pc_50
  s_waitcnt vmcnt(2)
  s_bitcmp1_b64 s[14:15], 46
  s_cbranch_scc0 L_pc_50
  s_waitcnt vmcnt(1)
L_pc_50:
  buffer_load_dwordx4 v1, s[52:55], s43 offen offset:2048 nt lds
  s_waitcnt vmcnt(3)
  s_bitcmp1_b64 s[58:59], 47
  s_cbranch_scc0 L_pc_51
  s_waitcnt vmcnt(2)
  s_bitcmp1_b64 s[14:15], 47
  s_cbranch_scc0 L_pc_51
  s_waitcnt vmcnt(1)
L_pc_51:
  buffer_load_dwordx4 v1, s[52:55], s43 offen offset:3072 nt lds
L_spin_52:
  ds_read_b32 v12, v38 offset:8
  s_waitcnt lgkmcnt(0)
  v_readfirstlane_b32 s60, v12
  s_nop 0
  s_cmp_ge_u32 s60, 1
  s_cbranch_scc1 L_spun_53
  s_add_u32 s64, s64, 1
  s_cmp_gt_u32 s64, 200000
  s_cbranch_scc1 L_exit
  s_sleep 1
  s_branch L_spin_52
L_spun_53:
  v_lshlrev_b32 v12, 4, v3
  ds_read_b128 v[8:11], v12 offset:256
  s_waitcnt lgkmcnt(0)
  v_dot2_f32_bf16 v12, v40, v8, 0
  v_dot2_f32_bf16 v13, v44, v8, 0
  v_dot2_f32_bf16 v14, v48, v8, 0
  v_dot2_f32_bf16 v15, v52, v8, 0
  v_dot2_f32_bf16 v12, v41, v9, v12
  v_dot2_f32_bf16 v13, v45, v9, v13
  v_dot2_f32_bf16 v14, v49, v9, v14
  v_dot2_f32_bf16 v15, v53, v9, v15
  v_dot2_f32_bf16 v12, v42, v10, v12
  v_dot2_f32_bf16 v13, v46, v10, v13
  v_dot2_f32_bf16 v14, v50, v10, v14
  v_dot2_f32_bf16 v15, v54, v10, v15
  v_dot2_f32_bf16 v12, v43, v11, v12
  v_dot2_f32_bf16 v13, v47, v11, v13
  v_dot2_f32_bf16 v14, v51, v11, v14
  v_dot2_f32_bf16 v15, v55, v11, v15
  v_add_f32_dpp v16, v12, v12 row_ror:8 row_mask:0xf bank_mask:0x3
  s_nop 0
  v_add_f32_dpp v17, v14, v14 row_ror:8 row_mask:0xf bank_mask:0x3
  v_add_f32_dpp v16, v13, v13 row_ror:8 row_mask:0xf bank_mask:0xc
  s_nop 0
  v_add_f32_dpp v17, v15, v15 row_ror:8 row_mask:0xf bank_mask:0xc
  v_add_f32_dpp v18, v16, v16 row_shl:4 row_mask:0xf bank_mask:0x5
  s_nop 1
  v_add_f32_dpp v18, v17, v17 row_shr:4 row_mask:0xf bank_mask:0xa
  s_nop 1
  v_add_f32_dpp v18, v18, v18 quad_perm:[1,0,3,2] row_mask:0xf bank_mask:0xf
  s_nop 1
  v_add_f32_dpp v18, v18, v18 quad_perm:[2,3,0,1] row_mask:0xf bank_mask:0xf
  s_waitcnt vmcnt(3)
  s_bitcmp1_b64 s[58:59], 48
  s_cbranch_scc0 L_pc_54
  s_waitcnt vmcnt(2)
  s_bitcmp1_b64 s[14:15], 48
  s_cbranch_scc0 L_pc_54
  s_waitcnt vmcnt(1)
L_pc_54:
  buffer_load_dwordx4 v[40:43], v1, s[52:55], s44 offen offset:0 nt
  v_dot2_f32_bf16 v12, v56, v8, 0
  v_dot2_f32_bf16 v13, v60, v8, 0
  v_dot2_f32_bf16 v14, v64, v8, 0
  v_dot2_f32_bf16 v15, v68, v8, 0
  v_dot2_f32_bf16 v12, v57, v9, v12
  v_dot2_f32_bf16 v13, v61, v9, v13
  v_dot2_f32_bf16 v14, v65, v9, v14
  v_dot2_f32_bf16 v15, v69, v9, v15
  v_dot2_f32_bf16 v12, v58, v10, v12
  v_dot2_f32_bf16 v13, v62, v10, v13
  v_dot2_f32_bf16 v14, v66, v10, v14
  v_dot2_f32_bf16 v15, v70, v10, v15
  v_dot2_f32_bf16 v12, v59, v11, v12
  v_dot2_f32_bf16 v13, v63, v11, v13
  v_dot2_f32_bf16 v14, v67, v11, v14
  v_dot2_f32_bf16 v15, v71, v11, v15
  v_add_f32_dpp v16, v12, v12 row_ror:8 row_mask:0xf bank_mask:0x3
  s_nop 0
  v_add_f32_dpp v17, v14, v14 row_ror:8 row_mask:0xf bank_mask:0x3
  v_add_f32_dpp v16, v13, v13 row_ror:8 row_mask:0xf bank_mask:0xc
  s_nop 0
  v_add_f32_dpp v17, v15, v15 row_ror:8 row_mask:0xf bank_mask:0xc
  v_add_f32_dpp v19, v16, v16 row_shl:4 row_mask:0xf bank_mask:0x5
  s_nop 1
  v_add_f32_dpp v19, v17, v17 row_shr:4 row_mask:0xf bank_mask:0xa
  s_nop 1
  v_add_f32_dpp v19, v19, v19 quad_perm:[1,0,3,2] row_mask:0xf bank_mask:0xf
  s_nop 1
  v_add_f32_dpp v19, v19, v19 quad_perm:[2,3,0,1] row_mask:0xf bank_mask:0xf
  v_dot2_f32_bf16 v12, v72, v8, 0
  v_dot2_f32_bf16 v13, v76, v8, 0
  v_dot2_f32_bf16 v14, v80, v8, 0
  v_dot2_f32_bf16 v15, v84, v8, 0
  v_dot2_f32_bf16 v12, v73, v9, v12
  v_dot2_f32_bf16 v13, v77, v9, v13
  v_dot2_f32_bf16 v14, v81, v9, v14
  v_dot2_f32_bf16 v15, v85, v9, v15
  v_dot2_f32_bf16 v12, v74, v10, v12
  v_dot2_f32_bf16 v13, v78, v10, v13
  v_dot2_f32_bf16 v14, v82, v10, v14
  v_dot2_f32_bf16 v15, v86, v10, v15
  v_dot2_f32_bf16 v12, v75, v11, v12
  v_dot2_f32_bf16 v13, v79, v11, v13
  v_dot2_f32_bf16 v14, v83, v11, v14
  v_dot2_f32_bf16 v15, v87, v11, v15
  v_add_f32_dpp v16, v12, v12 row_ror:8 row_mask:0xf bank_mask:0x3
  s_nop 0
  v_add_f32_dpp v17, v14, v14 row_ror:8 row_mask:0xf bank_mask:0x3
  v_add_f32_dpp v16, v13, v13 row_ror:8 row_mask:0xf bank_mask:0xc
  s_nop 0
  v_add_f32_dpp v17, v15, v15 row_ror:8 row_mask:0xf bank_mask:0xc
  v_add_f32_dpp v20, v16, v16 row_shl:4 row_mask:0xf bank_mask:0x5
  s_nop 1
  v_add_f32_dpp v20, v17, v17 row_shr:4 row_mask:0xf bank_mask:0xa
  s_nop 1
  v_add_f32_dpp v20, v20, v20 quad_perm:[1,0,3,2] row_mask:0xf bank_mask:0xf
  s_nop 1
  v_add_f32_dpp v20, v20, v20 quad_perm:[2,3,0,1] row_mask:0xf bank_mask:0xf
  s_waitcnt vmcnt(3)
  s_bitcmp1_b64 s[58:59], 49
  s_cbranch_scc0 L_pc_55
  s_waitcnt vmcnt(2)
  s_bitcmp1_b64 s[14:15], 49
  s_cbranch_scc0 L_pc_55
  s_waitcnt vmcnt(1)
L_pc_55:
  buffer_load_dwordx4 v[44:47], v1, s[52:55], s44 offen offset:1024 nt
  v_dot2_f32_bf16 v12, v88, v8, 0
  v_dot2_f32_bf16 v13, v92, v8, 0
  v_dot2_f32_bf16 v14, v96, v8, 0
  v_dot2_f32_bf16 v15, v100, v8, 0
  v_dot2_f32_bf16 v12, v89, v9, v12
  v_dot2_f32_bf16 v13, v93, v9, v13
  v_dot2_f32_bf16 v14, v97, v9, v14
  v_dot2_f32_bf16 v15, v101, v9, v15
  v_dot2_f32_bf16 v12, v90, v10, v12
  v_dot2_f32_bf16 v13, v94, v10, v13
  v_dot2_f32_bf16 v14, v98, v10, v14
  v_dot2_f32_bf16 v15, v102, v10, v15
  v_dot2_f32_bf16 v12, v91, v11, v12
  v_dot2_f32_bf16 v13, v95, v11, v13
  v_dot2_f32_bf16 v14, v99, v11, v14
  v_dot2_f32_bf16 v15, v103, v11, v15
  v_add_f32_dpp v16, v12, v12 row_ror:8 row_mask:0xf bank_mask:0x3
  s_nop 0
  v_add_f32_dpp v17, v14, v14 row_ror:8 row_mask:0xf bank_mask:0x3
  v_add_f32_dpp v16, v13, v13 row_ror:8 row_mask:0xf bank_mask:0xc
  s_nop 0
  v_add_f32_dpp v17, v15, v15 row_ror:8 row_mask:0xf bank_mask:0xc
  v_add_f32_dpp v21, v16, v16 row_shl:4 row_mask:0xf bank_mask:0x5
  s_nop 1
  v_add_f32_dpp v21, v17, v17 row_shr:4 row_mask:0xf bank_mask:0xa
  s_nop 1
  v_add_f32_dpp v21, v21, v21 quad_perm:[1,0,3,2] row_mask:0xf bank_mask:0xf
  s_nop 1
  v_add_f32_dpp v21, v21, v21 quad_perm:[2,3,0,1] row_mask:0xf bank_mask:0xf
  v_dot2_f32_bf16 v12, v104, v8, 0
  v_dot2_f32_bf16 v13, v108, v8, 0
  v_dot2_f32_bf16 v14, v112, v8, 0
  v_dot2_f32_bf16 v15, v116, v8, 0
  v_dot2_f32_bf16 v12, v105, v9, v12
  v_dot2_f32_bf16 v13, v109, v9, v13
  v_dot2_f32_bf16 v14, v113, v9, v14
  v_dot2_f32_bf16 v15, v117, v9, v15
  v_dot2_f32_bf16 v12, v106, v10, v12
  v_dot2_f32_bf16 v13, v110, v10, v13
  v_dot2_f32_bf16 v14, v114, v10, v14
  v_dot2_f32_bf16 v15, v118, v10, v15
  v_dot2_f32_bf16 v12, v107, v11, v12
  v_dot2_f32_bf16 v13, v111, v11, v13
  v_dot2_f32_bf16 v14, v115, v11, v14
  v_dot2_f32_bf16 v15, v119, v11, v15
  v_add_f32_dpp v16, v12, v12 row_ror:8 row_mask:0xf bank_mask:0x3
  s_nop 0
  v_add_f32_dpp v17, v14, v14 row_ror:8 row_mask:0xf bank_mask:0x3
  v_add_f32_dpp v16, v13, v13 row_ror:8 row_mask:0xf bank_mask:0xc
  s_nop 0
  v_add_f32_dpp v17, v15, v15 row_ror:8 row_mask:0xf bank_mask:0xc
  v_add_f32_dpp v22, v16, v16 row_shl:4 row_mask:0xf bank_mask:0x5
  s_nop 1
  v_add_f32_dpp v22, v17, v17 row_shr:4 row_mask:0xf bank_mask:0xa
  s_nop 1
  v_add_f32_dpp v22, v22, v22 quad_perm:[1,0,3,2] row_mask:0xf bank_mask:0xf
  s_nop 1
  v_add_f32_dpp v22, v22, v22 quad_perm:[2,3,0,1] row_mask:0xf bank_mask:0xf
  s_waitcnt vmcnt(3)
  s_bitcmp1_b64 s[58:59], 50
  s_cbranch_scc0 L_pc_56
  s_waitcnt vmcnt(2)
  s_bitcmp1_b64 s[14:15], 50
  s_cbranch_scc0 L_pc_56
  s_waitcnt vmcnt(1)
L_pc_56:
  buffer_load_dwordx4 v[48:51], v1, s[52:55], s44 offen offset:2048 nt
  v_dot2_f32_bf16 v12, v120, v8, 0
  v_dot2_f32_bf16 v13, v124, v8, 0
  v_dot2_f32_bf16 v14, v128, v8, 0
  v_dot2_f32_bf16 v15, v132, v8, 0
  v_dot2_f32_bf16 v12, v121, v9, v12
  v_dot2_f32_bf16 v13, v125, v9, v13
  v_dot2_f32_bf16 v14, v129, v9, v14
  v_dot2_f32_bf16 v15, v133, v9, v15
  v_dot2_f32_bf16 v12, v122, v10, v12
  v_dot2_f32_bf16 v13, v126, v10, v13
  v_dot2_f32_bf16 v14, v130, v10, v14
  v_dot2_f32_bf16 v15, v134, v10, v15
  v_dot2_f32_bf16 v12, v123, v11, v12
  v_dot2_f32_bf16 v13, v127, v11, v13
  v_dot2_f32_bf16 v14, v131, v11, v14
  v_dot2_f32_bf16 v15, v135, v11, v15
  v_add_f32_dpp v16, v12, v12 row_ror:8 row_mask:0xf bank_mask:0x3
  s_nop 0
  v_add_f32_dpp v17, v14, v14 row_ror:8 row_mask:0xf bank_mask:0x3
  v_add_f32_dpp v16, v13, v13 row_ror:8 row_mask:0xf bank_mask:0xc
  s_nop 0
  v_add_f32_dpp v17, v15, v15 row_ror:8 row_mask:0xf bank_mask:0xc
  v_add_f32_dpp v23, v16, v16 row_shl:4 row_mask:0xf bank_mask:0x5
  s_nop 1
  v_add_f32_dpp v23, v17, v17 row_shr:4 row_mask:0xf bank_mask:0xa
  s_nop 1
  v_add_f32_dpp v23, v23, v23 quad_perm:[1,0,3,2] row_mask:0xf bank_mask:0xf
  s_nop 1
  v_add_f32_dpp v23, v23, v23 quad_perm:[2,3,0,1] row_mask:0xf bank_mask:0xf
  v_dot2_f32_bf16 v12, v136, v8, 0
  v_dot2_f32_bf16 v13, v140, v8, 0
  v_dot2_f32_bf16 v14, v144, v8, 0
  v_dot2_f32_bf16 v15, v148, v8, 0
  v_dot2_f32_bf16 v12, v137, v9, v12
  v_dot2_f32_bf16 v13, v141, v9, v13
  v_dot2_f32_bf16 v14, v145, v9, v14
  v_dot2_f32_bf16 v15, v149, v9, v15
  v_dot2_f32_bf16 v12, v138, v10, v12
  v_dot2_f32_bf16 v13, v142, v10, v13
  v_dot2_f32_bf16 v14, v146, v10, v14
  v_dot2_f32_bf16 v15, v150, v10, v15
  v_dot2_f32_bf16 v12, v139, v11, v12
  v_dot2_f32_bf16 v13, v143, v11, v13
  v_dot2_f32_bf16 v14, v147, v11, v14
  v_dot2_f32_bf16 v15, v151, v11, v15
  v_add_f32_dpp v16, v12, v12 row_ror:8 row_mask:0xf bank_mask:0x3
  s_nop 0
  v_add_f32_dpp v17, v14, v14 row_ror:8 row_mask:0xf bank_mask:0x3
  v_add_f32_dpp v16, v13, v13 row_ror:8 row_mask:0xf bank_mask:0xc
  s_nop 0
  v_add_f32_dpp v17, v15, v15 row_ror:8 row_mask:0xf bank_mask:0xc
  v_add_f32_dpp v24, v16, v16 row_shl:4 row_mask:0xf bank_mask:0x5
  s_nop 1
  v_add_f32_dpp v24, v17, v17 row_shr:4 row_mask:0xf bank_mask:0xa
  s_nop 1
  v_add_f32_dpp v24, v24, v24 quad_perm:[1,0,3,2] row_mask:0xf bank_mask:0xf
  s_nop 1
  v_add_f32_dpp v24, v24, v24 quad_perm:[2,3,0,1] row_mask:0xf bank_mask:0xf
  s_waitcnt vmcnt(3)
  s_bitcmp1_b64 s[58:59], 51
  s_cbranch_scc0 L_pc_57
  s_waitcnt vmcnt(2)
  s_bitcmp1_b64 s[14:15], 51
  s_cbranch_scc0 L_pc_57
  s_waitcnt vmcnt(1)
L_pc_57:
  buffer_load_dwordx4 v[52:55], v1, s[52:55], s44 offen offset:3072 nt
  v_dot2_f32_bf16 v12, v152, v8, 0
  v_dot2_f32_bf16 v13, v156, v8, 0
  v_dot2_f32_bf16 v14, v160, v8, 0
  v_dot2_f32_bf16 v15, v164, v8, 0
  v_dot2_f32_bf16 v12, v153, v9, v12
  v_dot2_f32_bf16 v13, v157, v9, v13
  v_dot2_f32_bf16 v14, v161, v9, v14
  v_dot2_f32_bf16 v15, v165, v9, v15
  v_dot2_f32_bf16 v12, v154, v10, v12
  v_dot2_f32_bf16 v13, v158, v10, v13
  v_dot2_f32_bf16 v14, v162, v10, v14
  v_dot2_f32_bf16 v15, v166, v10, v15
  v_dot2_f32_bf16 v12, v155, v11, v12
  v_dot2_f32_bf16 v13, v159, v11, v13
  v_dot2_f32_bf16 v14, v163, v11, v14
  v_dot2_f32_bf16 v15, v167, v11, v15
  v_add_f32_dpp v16, v12, v12 row_ror:8 row_mask:0xf bank_mask:0x3
  s_nop 0
  v_add_f32_dpp v17, v14, v14 row_ror:8 row_mask:0xf bank_mask:0x3
  v_add_f32_dpp v16, v13, v13 row_ror:8 row_mask:0xf bank_mask:0xc
  s_nop 0
  v_add_f32_dpp v17, v15, v15 row_ror:8 row_mask:0xf bank_mask:0xc
  v_add_f32_dpp v25, v16, v16 row_shl:4 row_mask:0xf bank_mask:0x5
  s_nop 1
  v_add_f32_dpp v25, v17, v17 row_shr:4 row_mask:0xf bank_mask:0xa
  s_nop 1
  v_add_f32_dpp v25, v25, v25 quad_perm:[1,0,3,2] row_mask:0xf bank_mask:0xf
  s_nop 1
  v_add_f32_dpp v25, v25, v25 quad_perm:[2,3,0,1] row_mask:0xf bank_mask:0xf
  v_add_u32 v34, s56, v1
  ds_read_b128 v[104:107], v34 offset:0
  ds_read_b128 v[108:111], v34 offset:1024
  ds_read_b128 v[112:115], v34 offset:2048
  ds_read_b128 v[116:119], v34 offset:3072
  ds_read_b128 v[120:123], v34 offset:4096
  ds_read_b128 v[124:127], v34 offset:5120
  ds_read_b128 v[128:131], v34 offset:6144
  ds_read_b128 v[132:135], v34 offset:7168
  ds_read_b128 v[136:139], v34 offset:8192
  ds_read_b128 v[140:143], v34 offset:9216
  ds_read_b128 v[144:147], v34 offset:10240
  ds_read_b128 v[148:151], v34 offset:11264
  ds_read_b128 v[152:155], v34 offset:12288
  ds_read_b128 v[156:159], v34 offset:13312
  ds_read_b128 v[160:163], v34 offset:14336
  ds_read_b128 v[164:167], v34 offset:15360
  s_mov_b32 s60, 0x3db504f3
  v_cvt_pk_bf16_f32 v12, v18, v19
  v_lshlrev_b32 v18, 16, v12
  v_and_b32 v19, 0xffff0000, v12
  v_cvt_pk_bf16_f32 v13, v20, v21
  v_lshlrev_b32 v20, 16, v13
  v_and_b32 v21, 0xffff0000, v13
  v_cvt_pk_bf16_f32 v14, v22, v23
  v_lshlrev_b32 v22, 16, v14
  v_and_b32 v23, 0xffff0000, v14
  v_cvt_pk_bf16_f32 v15, v24, v25
  v_lshlrev_b32 v24, 16, v15
  v_and_b32 v25, 0xffff0000, v15
  v_mul_f32 v18, s60, v18
  v_mul_f32 v19, s60, v19
  v_mul_f32 v20, s60, v20
  v_mul_f32 v21, s60, v21
  v_mul_f32 v22, s60, v22
  v_mul_f32 v23, s60, v23
  v_mul_f32 v24, s60, v24
  v_mul_f32 v25, s60, v25
  v_cvt_pk_bf16_f32 v12, v18, v19
  v_lshlrev_b32 v18, 16, v12
  v_and_b32 v19, 0xffff0000, v12
  v_cvt_pk_bf16_f32 v13, v20, v21
  v_lshlrev_b32 v20, 16, v13
  v_and_b32 v21, 0xffff0000, v13
  v_cvt_pk_bf16_f32 v14, v22, v23
  v_lshlrev_b32 v22, 16, v14
  v_and_b32 v23, 0xffff0000, v14
  v_cvt_pk_bf16_f32 v15, v24, v25
  v_lshlrev_b32 v24, 16, v15
  v_and_b32 v25, 0xffff0000, v15
  v_max3_f32 v12, v18, v19, v20
  v_max3_f32 v13, v21, v22, v23
  v_max3_f32 v12, v12, v24, v25
  v_max_f32 v12, v12, v13
  s_nop 1
  v_max_f32_dpp v12, v12, v12 row_ror:4 row_mask:0xf bank_mask:0xf
  s_nop 1
  v_max_f32_dpp v12, v12, v12 row_ror:8 row_mask:0xf bank_mask:0xf
  s_nop 1
  v_max_f32_dpp v12, v12, v12 row_bcast:15 row_mask:0xa bank_mask:0xf
  s_nop 1
  v_max_f32_dpp v12, v12, v12 row_bcast:31 row_mask:0xc bank_mask:0xf
  s_nop 0
  v_readlane_b32 s61, v12, 63
  s_nop 1
  v_subrev_f32 v26, s61, v18
  v_subrev_f32 v27, s61, v19
  v_subrev_f32 v28, s61, v20
  v_subrev_f32 v29, s61, v21
  v_max_f32 v26, 0xc3480000, v26
  v_max_f32 v27, 0xc3480000, v27
  v_max_f32 v28, 0xc3480000, v28
  v_max_f32 v29, 0xc3480000, v29
  v_mul_f32 v30, s66, v26
  v_mul_f32 v31, s66, v27
  v_mul_f32 v32, s66, v28
  v_mul_f32 v33, s66, v29
  v_fma_f32 v8, v26, s66, -v30
  v_fma_f32 v9, v27, s66, -v31
  v_fma_f32 v10, v28, s66, -v32
  v_fma_f32 v11, v29, s66, -v33
  v_exp_f32 v30, v30
  v_exp_f32 v31, v31
  v_exp_f32 v32, v32
  v_exp_f32 v33, v33
  v_fmac_f32 v8, 0x32a57060, v26
  v_fmac_f32 v9, 0x32a57060, v27
  v_fmac_f32 v10, 0x32a57060, v28
  v_fmac_f32 v11, 0x32a57060, v29
  v_mul_f32 v8, 0x3f317218, v8
  v_mul_f32 v9, 0x3f317218, v9
  v_mul_f32 v10, 0x3f317218, v10
  v_mul_f32 v11, 0x3f317218, v11
  v_fmac_f32 v30, v30, v8
  v_fmac_f32 v31, v31, v9
  v_fmac_f32 v32, v32, v10
  v_fmac_f32 v33, v33, v11
  v_add_f32 v14, v30, v31
  v_add_f32 v15, v32, v33
  v_add_f32 v13, v14, v15
  v_subrev_f32 v26, s61, v22
  v_subrev_f32 v27, s61, v23
  v_subrev_f32 v28, s61, v24
  v_subrev_f32 v29, s61, v25
  v_max_f32 v26, 0xc3480000, v26
  v_max_f32 v27, 0xc3480000, v27
  v_max_f32 v28, 0xc3480000, v28
  v_max_f32 v29, 0xc3480000, v29
  v_mul_f32 v30, s66, v26
  v_mul_f32 v31, s66, v27
  v_mul_f32 v32, s66, v28
  v_mul_f32 v33, s66, v29
  v_fma_f32 v8, v26, s66, -v30
  v_fma_f32 v9, v27, s66, -v31
  v_fma_f32 v10, v28, s66, -v32
  v_fma_f32 v11, v29, s66, -v33
  v_exp_f32 v30, v30
  v_exp_f32 v31, v31
  v_exp_f32 v32, v32
  v_exp_f32 v33, v33
  v_fmac_f32 v8, 0x32a57060, v26
  v_fmac_f32 v9, 0x32a57060, v27
  v_fmac_f32 v10, 0x32a57060, v28
  v_fmac_f32 v11, 0x32a57060, v29
  v_mul_f32 v8, 0x3f317218, v8
  v_mul_f32 v9, 0x3f317218, v9
  v_mul_f32 v10, 0x3f317218, v10
  v_mul_f32 v11, 0x3f317218, v11
  v_fmac_f32 v30, v30, v8
  v_fmac_f32 v31, v31, v9
  v_fmac_f32 v32, v32, v10
  v_fmac_f32 v33, v33, v11
  v_add_f32 v14, v30, v31
  v_add_f32 v15, v32, v33
  v_add_f32 v14, v14, v15
  v_add_f32 v13, v13, v14
  s_nop 1
  v_add_f32_dpp v13, v13, v13 row_ror:4 row_mask:0xf bank_mask:0xf
  s_nop 1
  v_add_f32_dpp v13, v13, v13 row_ror:8 row_mask:0xf bank_mask:0xf
  s_nop 1
  v_add_f32_dpp v13, v13, v13 row_bcast:15 row_mask:0xa bank_mask:0xf
  s_nop 1
  v_add_f32_dpp v13, v13, v13 row_bcast:31 row_mask:0xc bank_mask:0xf
  s_lshl_b32 s60, s32, 3
  v_mov_b32 v14, s60
  s_mov_b32 exec_lo, 0
  s_mov_b32 exec_hi, 0x80000000
  ds_write_b64 v14, v[12:13] offset:64
  ds_add_u32 v38, v39 offset:12
  s_mov_b64 exec, -1
  s_waitcnt vmcnt(3)
  s_bitcmp1_b64 s[58:59], 52
  s_cbranch_scc0 L_pc_58
  s_waitcnt vmcnt(2)
  s_bitcmp1_b64 s[14:15], 52
  s_cbranch_scc0 L_pc_58
  s_waitcnt vmcnt(1)
L_pc_58:
  buffer_load_dwordx4 v[56:59], v1, s[52:55], s45 offen offset:0 nt
  s_waitcnt vmcnt(3)
  s_bitcmp1_b64 s[58:59], 53
  s_cbranch_scc0 L_pc_59
  s_waitcnt vmcnt(2)
  s_bitcmp1_b64 s[14:15], 53
  s_cbranch_scc0 L_pc_59
  s_waitcnt vmcnt(1)
L_pc_59:
  buffer_load_dwordx4 v[60:63], v1, s[52:55], s45 offen offset:1024 nt
L_spin_60:
  ds_read_b32 v12, v38 offset:12
  s_waitcnt lgkmcnt(0)
  v_readfirstlane_b32 s60, v12
  s_nop 0
  s_cmp_ge_u32 s60, 8
  s_cbranch_scc1 L_spun_61
  s_add_u32 s64, s64, 1
  s_cmp_gt_u32 s64, 200000
  s_cbranch_scc1 L_exit
  s_sleep 1
  s_branch L_spin_60
L_spun_61:
  v_and_b32 v14, 7, v0
  v_lshlrev_b32 v14, 3, v14
  ds_read_b64 v[12:13], v14 offset:64
  s_waitcnt lgkmcnt(0)
  v_mov_b32 v14, v12
  s_nop 1
  v_max_f32_dpp v14, v14, v14 quad_perm:[1,0,3,2] row_mask:0xf bank_mask:0xf
  s_nop 1
  v_max_f32_dpp v14, v14, v14 quad_perm:[2,3,0,1] row_mask:0xf bank_mask:0xf
  s_nop 1
  v_max_f32_dpp v14, v14, v14 row_ror:4 row_mask:0xf bank_mask:0xf
  v_sub_f32 v12, v12, v14
  v_max_f32 v12, 0xc3480000, v12
  v_mul_f32 v15, s66, v12
  v_fma_f32 v16, v12, s66, -v15
  v_exp_f32 v15, v15
  v_fmac_f32 v16, 0x32a57060, v12
  v_mul_f32 v16, 0x3f317218, v16
  v_fmac_f32 v15, v15, v16
  v_mul_f32 v13, v13, v15
  s_nop 1
  v_add_f32_dpp v13, v13, v13 quad_perm:[1,0,3,2] row_mask:0xf bank_mask:0xf
  s_nop 1
  v_add_f32_dpp v13, v13, v13 quad_perm:[2,3,0,1] row_mask:0xf bank_mask:0xf
  s_nop 1
  v_add_f32_dpp v13, v13, v13 row_ror:4 row_mask:0xf bank_mask:0xf
  v_sub_f32 v8, v18, v14
  v_sub_f32 v9, v19, v14
  v_sub_f32 v10, v20, v14
  v_sub_f32 v11, v21, v14
  v_max_f32 v8, 0xc3480000, v8
  v_max_f32 v9, 0xc3480000, v9
  v_max_f32 v10, 0xc3480000, v10
  v_max_f32 v11, 0xc3480000, v11
  v_mul_f32 v26, s66, v8
  v_mul_f32 v27, s66, v9
  v_mul_f32 v28, s66, v10
  v_mul_f32 v29, s66, v11
  v_fma_f32 v34, v8, s66, -v26
  v_fma_f32 v35, v9, s66, -v27
  v_fma_f32 v36, v10, s66, -v28
  v_fma_f32 v37, v11, s66, -v29
  v_exp_f32 v26, v26
  v_exp_f32 v27, v27
  v_exp_f32 v28, v28
  v_exp_f32 v29, v29
  v_fmac_f32 v34, 0x32a57060, v8
  v_fmac_f32 v35, 0x32a57060, v9
  v_fmac_f32 v36, 0x32a57060, v10
  v_fmac_f32 v37, 0x32a57060, v11
  v_mul_f32 v34, 0x3f317218, v34
  v_mul_f32 v35, 0x3f317218, v35
  v_mul_f32 v36, 0x3f317218, v36
  v_mul_f32 v37, 0x3f317218, v37
  v_fmac_f32 v26, v26, v34
  v_fmac_f32 v27, v27, v35
  v_fmac_f32 v28, v28, v36
  v_fmac_f32 v29, v29, v37
  v_sub_f32 v8, v22, v14
  v_sub_f32 v9, v23, v14
  v_sub_f32 v10, v24, v14
  v_sub_f32 v11, v25, v14
  v_max_f32 v8, 0xc3480000, v8
  v_max_f32 v9, 0xc3480000, v9
  v_max_f32 v10, 0xc3480000, v10
  v_max_f32 v11, 0xc3480000, v11
  v_mul_f32 v30, s66, v8
  v_mul_f32 v31, s66, v9
  v_mul_f32 v32, s66, v10
  v_mul_f32 v33, s66, v11
  v_fma_f32 v34, v8, s66, -v30
  v_fma_f32 v35, v9, s66, -v31
  v_fma_f32 v36, v10, s66, -v32
  v_fma_f32 v37, v11, s66, -v33
  v_exp_f32 v30, v30
  v_exp_f32 v31, v31
  v_exp_f32 v32, v32
  v_exp_f32 v33, v33
  v_fmac_f32 v34, 0x32a57060, v8
  v_fmac_f32 v35, 0x32a57060, v9
  v_fmac_f32 v36, 0x32a57060, v10
  v_fmac_f32 v37, 0x32a57060, v11
  v_mul_f32 v34, 0x3f317218, v34
  v_mul_f32 v35, 0x3f317218, v35
  v_mul_f32 v36, 0x3f317218, v36
  v_mul_f32 v37, 0x3f317218, v37
  v_fmac_f32 v30, v30, v34
  v_fmac_f32 v31, v31, v35
  v_fmac_f32 v32, v32, v36
  v_fmac_f32 v33, v33, v37
  v_rcp_f32 v16, v13
  s_nop 0
  v_fma_f32 v17, -v13, v16, 1.0
  v_fmac_f32 v16, v17, v16
  v_fma_f32 v17, -v13, v16, 1.0
  v_fma_f32 v15, v17, v16, v16
  v_mul_f32 v26, v26, v15
  v_mul_f32 v27, v27, v15
  v_mul_f32 v28, v28, v15
  v_mul_f32 v29, v29, v15
  v_mul_f32 v30, v30, v15
  v_mul_f32 v31, v31, v15
  v_mul_f32 v32, v32, v15
  v_mul_f32 v33, v33, v15
  v_cvt_pk_bf16_f32 v18, v26, v26
  v_cvt_pk_bf16_f32 v19, v27, v27
  v_cvt_pk_bf16_f32 v20, v28, v28
  v_cvt_pk_bf16_f32 v21, v29, v29
  v_cvt_pk_bf16_f32 v22, v30, v30
  v_cvt_pk_bf16_f32 v23, v31, v31
  v_cvt_pk_bf16_f32 v24, v32, v32
  v_cvt_pk_bf16_f32 v25, v33, v33
  v_cmp_gt_u32 vcc, 8, v3
  v_mov_b32 v12, s18
  v_mov_b32 v13, s19
  v_mov_b32 v14, s16
  v_mov_b32 v15, s17
  v_cndmask_b32 v8, v12, v14, vcc
  v_cndmask_b32 v9, v13, v15, vcc
  s_lshr_b32 s16, s36, 1
  s_and_b32 s17, s36, 1
  s_lshl_b32 s60, s32, 6
  s_lshl_b32 s61, s16, 5
  s_add_u32 s60, s60, s61
  s_lshl_b32 s61, s17, 2
  s_add_u32 s60, s60, s61
  v_lshl_add_u32 v12, v2, 3, s60
  v_mul_u32_u24 v12, 2752, v12
  v_and_b32 v13, 7, v3
  v_lshl_add_u32 v12, v13, 3, v12
  s_lshl_b32 s60, s38, 6
  v_add_u32 v12, s60, v12
  v_mov_b32 v13, 0
  v_lshl_add_u64 v[8:9], v[8:9], 0, v[12:13]
  s_mov_b32 s10, 5504
  s_mov_b32 s11, 0
  s_cmp_eq_u32 s17, 0
  s_cselect_b32 s60, 4, -4
  s_cmp_eq_u32 s16, 0
  s_cselect_b32 s61, 32, -32
  s_sub_i32 s61, s61, s60
  s_sub_i32 s60, s60, 2
  s_sub_i32 s61, s61, 2
  s_mul_i32 s12, s60, 2752
  s_ashr_i32 s13, s12, 31
  s_mul_i32 s6, s61, 2752
  s_ashr_i32 s7, s6, 31
  s_mov_b32 s48, s20
  s_mov_b32 s49, s21
  s_mov_b32 s50, 1409024
  s_mov_b32 s51, 0x20000
  v_lshlrev_b32 v10, 13, v2
  v_lshl_add_u32 v10, v3, 3, v10
  s_lshl_b32 s18, s38, 15
  s_lshl_b32 s19, s32, 7
  s_add_u32 s18, s18, s19
  s_add_u32 s19, s18, 4096
L_spin_62:
  ds_read_b32 v12, v38 offset:28
  s_waitcnt lgkmcnt(0)
  v_readfirstlane_b32 s60, v12
  s_nop 0
  s_cmp_ge_u32 s60, 1
  s_cbranch_scc1 L_spun_63
  s_add_u32 s64, s64, 1
  s_cmp_gt_u32 s64, 200000
  s_cbranch_scc1 L_exit
  s_sleep 1
  s_branch L_spin_62
L_spun_63:
  ds_read_b32 v11, v38 offset:52
  s_waitcnt vmcnt(3)
  s_bitcmp1_b64 s[58:59], 54
  s_cbranch_scc0 L_pc_64
  s_waitcnt vmcnt(2)
  s_bitcmp1_b64 s[14:15], 54
  s_cbranch_scc0 L_pc_64
  s_waitcnt vmcnt(1)
L_pc_64:
  buffer_load_dwordx4 v[64:67], v1, s[52:55], s45 offen offset:2048 nt
  v_and_b32_dpp v26, v18, v4 row_newbcast:0 row_mask:0xf bank_mask:0xf
  v_and_b32_dpp v27, v18, v5 row_newbcast:0 row_mask:0xf bank_mask:0xf
  v_and_b32_dpp v28, v18, v6 row_newbcast:0 row_mask:0xf bank_mask:0xf
  v_and_b32_dpp v29, v18, v7 row_newbcast:0 row_mask:0xf bank_mask:0xf
  s_nop 1
  v_mfma_f32_16x16x32_bf16 v[34:37], v[26:29], v[104:107], 0
  v_and_b32_dpp v30, v18, v4 row_newbcast:8 row_mask:0xf bank_mask:0xf
  v_and_b32_dpp v31, v18, v5 row_newbcast:8 row_mask:0xf bank_mask:0xf
  v_and_b32_dpp v32, v18, v6 row_newbcast:8 row_mask:0xf bank_mask:0xf
  v_and_b32_dpp v33, v18, v7 row_newbcast:8 row_mask:0xf bank_mask:0xf
  s_nop 1
  v_mfma_f32_16x16x32_bf16 v[34:37], v[30:33], v[108:111], v[34:37]
  v_and_b32_dpp v26, v18, v4 row_newbcast:4 row_mask:0xf bank_mask:0xf
  v_and_b32_dpp v27, v18, v5 row_newbcast:4 row_mask:0xf bank_mask:0xf
  v_and_b32_dpp v28, v18, v6 row_newbcast:4 row_mask:0xf bank_mask:0xf
  v_and_b32_dpp v29, v18, v7 row_newbcast:4 row_mask:0xf bank_mask:0xf
  s_nop 1
  v_mfma_f32_16x16x32_bf16 v[34:37], v[26:29], v[112:115], v[34:37]
  s_waitcnt vmcnt(3)
  s_bitcmp1_b64 s[58:59], 55
  s_cbranch_scc0 L_pc_65
  s_waitcnt vmcnt(2)
  s_bitcmp1_b64 s[14:15], 55
  s_cbranch_scc0 L_pc_65
  s_waitcnt vmcnt(1)
L_pc_65:
  buffer_load_dwordx4 v[68:71], v1, s[52:55], s45 offen offset:3072 nt
  v_and_b32_dpp v30, v18, v4 row_newbcast:12 row_mask:0xf bank_mask:0xf
  v_and_b32_dpp v31, v18, v5 row_newbcast:12 row_mask:0xf bank_mask:0xf
  v_and_b32_dpp v32, v18, v6 row_newbcast:12 row_mask:0xf bank_mask:0xf
  v_and_b32_dpp v33, v18, v7 row_newbcast:12 row_mask:0xf bank_mask:0xf
  s_nop 1
  v_mfma_f32_16x16x32_bf16 v[34:37], v[30:33], v[116:119], v[34:37]
  v_and_b32_dpp v26, v19, v4 row_newbcast:0 row_mask:0xf bank_mask:0xf
  v_and_b32_dpp v27, v19, v5 row_newbcast:0 row_mask:0xf bank_mask:0xf
  v_and_b32_dpp v28, v19, v6 row_newbcast:0 row_mask:0xf bank_mask:0xf
  v_and_b32_dpp v29, v19, v7 row_newbcast:0 row_mask:0xf bank_mask:0xf
  s_nop 1
  v_mfma_f32_16x16x32_bf16 v[34:37], v[26:29], v[120:123], v[34:37]
  v_and_b32_dpp v30, v19, v4 row_newbcast:8 row_mask:0xf bank_mask:0xf
  v_and_b32_dpp v31, v19, v5 row_newbcast:8 row_mask:0xf bank_mask:0xf
  v_and_b32_dpp v32, v19, v6 row_newbcast:8 row_mask:0xf bank_mask:0xf
  v_and_b32_dpp v33, v19, v7 row_newbcast:8 row_mask:0xf bank_mask:0xf
  s_nop 1
  v_mfma_f32_16x16x32_bf16 v[34:37], v[30:33], v[124:127], v[34:37]
  s_waitcnt vmcnt(3)
  s_bitcmp1_b64 s[58:59], 56
  s_cbranch_scc0 L_pc_66
  s_waitcnt vmcnt(2)
  s_bitcmp1_b64 s[14:15], 56
  s_cbranch_scc0 L_pc_66
  s_waitcnt vmcnt(1)
L_pc_66:
  buffer_load_dwordx4 v[72:75], v1, s[52:55], s46 offen offset:0 nt
  v_and_b32_dpp v26, v19, v4 row_newbcast:4 row_mask:0xf bank_mask:0xf
  v_and_b32_dpp v27, v19, v5 row_newbcast:4 row_mask:0xf bank_mask:0xf
  v_and_b32_dpp v28, v19, v6 row_newbcast:4 row_mask:0xf bank_mask:0xf
  v_and_b32_dpp v29, v19, v7 row_newbcast:4 row_mask:0xf bank_mask:0xf
  s_nop 1
  v_mfma_f32_16x16x32_bf16 v[34:37], v[26:29], v[128:131], v[34:37]
  v_and_b32_dpp v30, v19, v4 row_newbcast:12 row_mask:0xf bank_mask:0xf
  v_and_b32_dpp v31, v19, v5 row_newbcast:12 row_mask:0xf bank_mask:0xf
  v_and_b32_dpp v32, v19, v6 row_newbcast:12 row_mask:0xf bank_mask:0xf
  v_and_b32_dpp v33, v19, v7 row_newbcast:12 row_mask:0xf bank_mask:0xf
  s_nop 1
  v_mfma_f32_16x16x32_bf16 v[34:37], v[30:33], v[132:135], v[34:37]
  v_and_b32_dpp v26, v20, v4 row_newbcast:0 row_mask:0xf bank_mask:0xf
  v_and_b32_dpp v27, v20, v5 row_newbcast:0 row_mask:0xf bank_mask:0xf
  v_and_b32_dpp v28, v20, v6 row_newbcast:0 row_mask:0xf bank_mask:0xf
  v_and_b32_dpp v29, v20, v7 row_newbcast:0 row_mask:0xf bank_mask:0xf
  s_nop 1
  v_mfma_f32_16x16x32_bf16 v[34:37], v[26:29], v[136:139], v[34:37]
  s_waitcnt vmcnt(3)
  s_bitcmp1_b64 s[58:59], 57
  s_cbranch_scc0 L_pc_67
  s_waitcnt vmcnt(2)
  s_bitcmp1_b64 s[14:15], 57
  s_cbranch_scc0 L_pc_67
  s_waitcnt vmcnt(1)
L_pc_67:
  buffer_load_dwordx4 v[76:79], v1, s[52:55], s46 offen offset:1024 nt
  v_and_b32_dpp v30, v20, v4 row_newbcast:8 row_mask:0xf bank_mask:0xf
  v_and_b32_dpp v31, v20, v5 row_newbcast:8 row_mask:0xf bank_mask:0xf
  v_and_b32_dpp v32, v20, v6 row_newbcast:8 row_mask:0xf bank_mask:0xf
  v_and_b32_dpp v33, v20, v7 row_newbcast:8 row_mask:0xf bank_mask:0xf
  s_nop 1
  v_mfma_f32_16x16x32_bf16 v[34:37], v[30:33], v[140:143], v[34:37]
  v_and_b32_dpp v26, v20, v4 row_newbcast:4 row_mask:0xf bank_mask:0xf
  v_and_b32_dpp v27, v20, v5 row_newbcast:4 row_mask:0xf bank_mask:0xf
  v_and_b32_dpp v28, v20, v6 row_newbcast:4 row_mask:0xf bank_mask:0xf
  v_and_b32_dpp v29, v20, v7 row_newbcast:4 row_mask:0xf bank_mask:0xf
  s_nop 1
  v_mfma_f32_16x16x32_bf16 v[34:37], v[26:29], v[144:147], v[34:37]
  v_and_b32_dpp v30, v20, v4 row_newbcast:12 row_mask:0xf bank_mask:0xf
  v_and_b32_dpp v31, v20, v5 row_newbcast:12 row_mask:0xf bank_mask:0xf
  v_and_b32_dpp v32, v20, v6 row_newbcast:12 row_mask:0xf bank_mask:0xf
  v_and_b32_dpp v33, v20, v7 row_newbcast:12 row_mask:0xf bank_mask:0xf
  s_nop 1
  v_mfma_f32_16x16x32_bf16 v[34:37], v[30:33], v[148:151], v[34:37]
  s_waitcnt vmcnt(3)
  s_bitcmp1_b64 s[58:59], 58
  s_cbranch_scc0 L_pc_68
  s_waitcnt vmcnt(2)
  s_bitcmp1_b64 s[14:15], 58
  s_cbranch_scc0 L_pc_68
  s_waitcnt vmcnt(1)
L_pc_68:
  buffer_load_dwordx4 v[80:83], v1, s[52:55], s46 offen offset:2048 nt
  v_and_b32_dpp v26, v21, v4 row_newbcast:0 row_mask:0xf bank_mask:0xf
  v_and_b32_dpp v27, v21, v5 row_newbcast:0 row_mask:0xf bank_mask:0xf
  v_and_b32_dpp v28, v21, v6 row_newbcast:0 row_mask:0xf bank_mask:0xf
  v_and_b32_dpp v29, v21, v7 row_newbcast:0 row_mask:0xf bank_mask:0xf
  s_nop 1
  v_mfma_f32_16x16x32_bf16 v[34:37], v[26:29], v[152:155], v[34:37]
  v_and_b32_dpp v30, v21, v4 row_newbcast:8 row_mask:0xf bank_mask:0xf
  v_and_b32_dpp v31, v21, v5 row_newbcast:8 row_mask:0xf bank_mask:0xf
  v_and_b32_dpp v32, v21, v6 row_newbcast:8 row_mask:0xf bank_mask:0xf
  v_and_b32_dpp v33, v21, v7 row_newbcast:8 row_mask:0xf bank_mask:0xf
  s_nop 1
  v_mfma_f32_16x16x32_bf16 v[34:37], v[30:33], v[156:159], v[34:37]
  v_and_b32_dpp v26, v21, v4 row_newbcast:4 row_mask:0xf bank_mask:0xf
  v_and_b32_dpp v27, v21, v5 row_newbcast:4 row_mask:0xf bank_mask:0xf
  v_and_b32_dpp v28, v21, v6 row_newbcast:4 row_mask:0xf bank_mask:0xf
  v_and_b32_dpp v29, v21, v7 row_newbcast:4 row_mask:0xf bank_mask:0xf
  s_nop 1
  v_mfma_f32_16x16x32_bf16 v[34:37], v[26:29], v[160:163], v[34:37]
  s_waitcnt vmcnt(3)
  s_bitcmp1_b64 s[58:59], 59
  s_cbranch_scc0 L_pc_69
  s_waitcnt vmcnt(2)
  s_bitcmp1_b64 s[14:15], 59
  s_cbranch_scc0 L_pc_69
  s_waitcnt vmcnt(1)
L_pc_69:
  buffer_load_dwordx4 v[84:87], v1, s[52:55], s46 offen offset:3072 nt
  v_and_b32_dpp v30, v21, v4 row_newbcast:12 row_mask:0xf bank_mask:0xf
  v_and_b32_dpp v31, v21, v5 row_newbcast:12 row_mask:0xf bank_mask:0xf
  v_and_b32_dpp v32, v21, v6 row_newbcast:12 row_mask:0xf bank_mask:0xf
  v_and_b32_dpp v33, v21, v7 row_newbcast:12 row_mask:0xf bank_mask:0xf
  s_nop 1
  v_mfma_f32_16x16x32_bf16 v[34:37], v[30:33], v[164:167], v[34:37]
  v_and_b32_dpp v26, v22, v4 row_newbcast:0 row_mask:0xf bank_mask:0xf
  v_and_b32_dpp v27, v22, v5 row_newbcast:0 row_mask:0xf bank_mask:0xf
  v_and_b32_dpp v28, v22, v6 row_newbcast:0 row_mask:0xf bank_mask:0xf
  v_and_b32_dpp v29, v22, v7 row_newbcast:0 row_mask:0xf bank_mask:0xf
  s_nop 1
  v_mfma_f32_16x16x32_bf16 v[34:37], v[26:29], v[40:43], v[34:37]
  v_and_b32_dpp v30, v22, v4 row_newbcast:8 row_mask:0xf bank_mask:0xf
  v_and_b32_dpp v31, v22, v5 row_newbcast:8 row_mask:0xf bank_mask:0xf
  v_and_b32_dpp v32, v22, v6 row_newbcast:8 row_mask:0xf bank_mask:0xf
  v_and_b32_dpp v33, v22, v7 row_newbcast:8 row_mask:0xf bank_mask:0xf
  s_nop 1
  v_mfma_f32_16x16x32_bf16 v[34:37], v[30:33], v[44:47], v[34:37]
  s_waitcnt vmcnt(3)
  s_bitcmp1_b64 s[58:59], 60
  s_cbranch_scc0 L_pc_70
  s_waitcnt vmcnt(2)
  s_bitcmp1_b64 s[14:15], 60
  s_cbranch_scc0 L_pc_70
  s_waitcnt vmcnt(1)
L_pc_70:
  buffer_load_dwordx4 v[88:91], v1, s[52:55], s47 offen offset:0 nt
  v_and_b32_dpp v26, v22, v4 row_newbcast:4 row_mask:0xf bank_mask:0xf
  v_and_b32_dpp v27, v22, v5 row_newbcast:4 row_mask:0xf bank_mask:0xf
  v_and_b32_dpp v28, v22, v6 row_newbcast:4 row_mask:0xf bank_mask:0xf
  v_and_b32_dpp v29, v22, v7 row_newbcast:4 row_mask:0xf bank_mask:0xf
  s_nop 1
  v_mfma_f32_16x16x32_bf16 v[34:37], v[26:29], v[48:51], v[34:37]
  v_and_b32_dpp v30, v22, v4 row_newbcast:12 row_mask:0xf bank_mask:0xf
  v_and_b32_dpp v31, v22, v5 row_newbcast:12 row_mask:0xf bank_mask:0xf
  v_and_b32_dpp v32, v22, v6 row_newbcast:12 row_mask:0xf bank_mask:0xf
  v_and_b32_dpp v33, v22, v7 row_newbcast:12 row_mask:0xf bank_mask:0xf
  s_nop 1
  v_mfma_f32_16x16x32_bf16 v[34:37], v[30:33], v[52:55], v[34:37]
  v_and_b32_dpp v26, v23, v4 row_newbcast:0 row_mask:0xf bank_mask:0xf
  v_and_b32_dpp v27, v23, v5 row_newbcast:0 row_mask:0xf bank_mask:0xf
  v_and_b32_dpp v28, v23, v6 row_newbcast:0 row_mask:0xf bank_mask:0xf
  v_and_b32_dpp v29, v23, v7 row_newbcast:0 row_mask:0xf bank_mask:0xf
  s_nop 1
  v_mfma_f32_16x16x32_bf16 v[34:37], v[26:29], v[56:59], v[34:37]
  s_waitcnt vmcnt(3)
  s_bitcmp1_b64 s[58:59], 61
  s_cbranch_scc0 L_pc_71
  s_waitcnt vmcnt(2)
  s_bitcmp1_b64 s[14:15], 61
  s_cbranch_scc0 L_pc_71
  s_waitcnt vmcnt(1)
L_pc_71:
  buffer_load_dwordx4 v[92:95], v1, s[52:55], s47 offen offset:1024 nt
  v_and_b32_dpp v30, v23, v4 row_newbcast:8 row_mask:0xf bank_mask:0xf
  v_and_b32_dpp v31, v23, v5 row_newbcast:8 row_mask:0xf bank_mask:0xf
  v_and_b32_dpp v32, v23, v6 row_newbcast:8 row_mask:0xf bank_mask:0xf
  v_and_b32_dpp v33, v23, v7 row_newbcast:8 row_mask:0xf bank_mask:0xf
  s_nop 1
  v_mfma_f32_16x16x32_bf16 v[34:37], v[30:33], v[60:63], v[34:37]
  v_and_b32_dpp v26, v23, v4 row_newbcast:4 row_mask:0xf bank_mask:0xf
  v_and_b32_dpp v27, v23, v5 row_newbcast:4 row_mask:0xf bank_mask:0xf
  v_and_b32_dpp v28, v23, v6 row_newbcast:4 row_mask:0xf bank_mask:0xf
  v_and_b32_dpp v29, v23, v7 row_newbcast:4 row_mask:0xf bank_mask:0xf
  s_nop 1
  v_mfma_f32_16x16x32_bf16 v[34:37], v[26:29], v[64:67], v[34:37]
  v_and_b32_dpp v30, v23, v4 row_newbcast:12 row_mask:0xf bank_mask:0xf
  v_and_b32_dpp v31, v23, v5 row_newbcast:12 row_mask:0xf bank_mask:0xf
  v_and_b32_dpp v32, v23, v6 row_newbcast:12 row_mask:0xf bank_mask:0xf
  v_and_b32_dpp v33, v23, v7 row_newbcast:12 row_mask:0xf bank_mask:0xf
  s_nop 1
  v_mfma_f32_16x16x32_bf16 v[34:37], v[30:33], v[68:71], v[34:37]
  s_waitcnt vmcnt(3)
  s_bitcmp1_b64 s[58:59], 62
  s_cbranch_scc0 L_pc_72
  s_waitcnt vmcnt(2)
  s_bitcmp1_b64 s[14:15], 62
  s_cbranch_scc0 L_pc_72
  s_waitcnt vmcnt(1)
L_pc_72:
  buffer_load_dwordx4 v[96:99], v1, s[52:55], s47 offen offset:2048 nt
  v_and_b32_dpp v26, v24, v4 row_newbcast:0 row_mask:0xf bank_mask:0xf
  v_and_b32_dpp v27, v24, v5 row_newbcast:0 row_mask:0xf bank_mask:0xf
  v_and_b32_dpp v28, v24, v6 row_newbcast:0 row_mask:0xf bank_mask:0xf
  v_and_b32_dpp v29, v24, v7 row_newbcast:0 row_mask:0xf bank_mask:0xf
  s_nop 1
  v_mfma_f32_16x16x32_bf16 v[34:37], v[26:29], v[72:75], v[34:37]
  v_and_b32_dpp v30, v24, v4 row_newbcast:8 row_mask:0xf bank_mask:0xf
  v_and_b32_dpp v31, v24, v5 row_newbcast:8 row_mask:0xf bank_mask:0xf
  v_and_b32_dpp v32, v24, v6 row_newbcast:8 row_mask:0xf bank_mask:0xf
  v_and_b32_dpp v33, v24, v7 row_newbcast:8 row_mask:0xf bank_mask:0xf
  s_nop 1
  v_mfma_f32_16x16x32_bf16 v[34:37], v[30:33], v[76:79], v[34:37]
  v_and_b32_dpp v26, v24, v4 row_newbcast:4 row_mask:0xf bank_mask:0xf
  v_and_b32_dpp v27, v24, v5 row_newbcast:4 row_mask:0xf bank_mask:0xf
  v_and_b32_dpp v28, v24, v6 row_newbcast:4 row_mask:0xf bank_mask:0xf
  v_and_b32_dpp v29, v24, v7 row_newbcast:4 row_mask:0xf bank_mask:0xf
  s_nop 1
  v_mfma_f32_16x16x32_bf16 v[34:37], v[26:29], v[80:83], v[34:37]
  s_waitcnt vmcnt(3)
  s_bitcmp1_b64 s[58:59], 63
  s_cbranch_scc0 L_pc_73
  s_waitcnt vmcnt(2)
  s_bitcmp1_b64 s[14:15], 63
  s_cbranch_scc0 L_pc_73
  s_waitcnt vmcnt(1)
L_pc_73:
  buffer_load_dwordx4 v[100:103], v1, s[52:55], s47 offen offset:3072 nt
  v_and_b32_dpp v30, v24, v4 row_newbcast:12 row_mask:0xf bank_mask:0xf
  v_and_b32_dpp v31, v24, v5 row_newbcast:12 row_mask:0xf bank_mask:0xf
  v_and_b32_dpp v32, v24, v6 row_newbcast:12 row_mask:0xf bank_mask:0xf
  v_and_b32_dpp v33, v24, v7 row_newbcast:12 row_mask:0xf bank_mask:0xf
  s_nop 1
  v_mfma_f32_16x16x32_bf16 v[34:37], v[30:33], v[84:87], v[34:37]
  s_cmp_lg_u32 s39, 0
  s_cbranch_scc1 L_vffn_74
  s_waitcnt vmcnt(3)
  v_and_b32_dpp v26, v25, v4 row_newbcast:0 row_mask:0xf bank_mask:0xf
  v_and_b32_dpp v27, v25, v5 row_newbcast:0 row_mask:0xf bank_mask:0xf
  v_and_b32_dpp v28, v25, v6 row_newbcast:0 row_mask:0xf bank_mask:0xf
  v_and_b32_dpp v29, v25, v7 row_newbcast:0 row_mask:0xf bank_mask:0xf
  s_nop 1
  v_mfma_f32_16x16x32_bf16 v[34:37], v[26:29], v[88:91], v[34:37]
  s_mov_b64 exec, 1
  ds_add_rtn_u32 v12, v38, v39 offset:32
  s_mov_b32 s5, 0
  s_waitcnt lgkmcnt(0)
  v_readfirstlane_b32 s60, v12
  s_mov_b64 exec, -1
  s_cmp_lg_u32 s60, 7
  s_cbranch_scc1 L_ht_75
  s_lshl_b32 s60, s35, 12
  s_add_u32 s60, s60, 68608
  s_mov_b32 s5, 1
  s_atomic_add s5, s[30:31], s60 glc
L_ht_75:
  s_waitcnt vmcnt(2)
  v_and_b32_dpp v30, v25, v4 row_newbcast:8 row_mask:0xf bank_mask:0xf
  v_and_b32_dpp v31, v25, v5 row_newbcast:8 row_mask:0xf bank_mask:0xf
  v_and_b32_dpp v32, v25, v6 row_newbcast:8 row_mask:0xf bank_mask:0xf
  v_and_b32_dpp v33, v25, v7 row_newbcast:8 row_mask:0xf bank_mask:0xf
  s_nop 1
  v_mfma_f32_16x16x32_bf16 v[34:37], v[30:33], v[92:95], v[34:37]
  s_waitcnt vmcnt(1)
  v_and_b32_dpp v26, v25, v4 row_newbcast:4 row_mask:0xf bank_mask:0xf
  v_and_b32_dpp v27, v25, v5 row_newbcast:4 row_mask:0xf bank_mask:0xf
  v_and_b32_dpp v28, v25, v6 row_newbcast:4 row_mask:0xf bank_mask:0xf
  v_and_b32_dpp v29, v25, v7 row_newbcast:4 row_mask:0xf bank_mask:0xf
  s_nop 1
  v_mfma_f32_16x16x32_bf16 v[34:37], v[26:29], v[96:99], v[34:37]
  s_waitcnt vmcnt(0)
  v_and_b32_dpp v30, v25, v4 row_newbcast:12 row_mask:0xf bank_mask:0xf
  v_and_b32_dpp v31, v25, v5 row_newbcast:12 row_mask:0xf bank_mask:0xf
  v_and_b32_dpp v32, v25, v6 row_newbcast:12 row_mask:0xf bank_mask:0xf
  v_and_b32_dpp v33, v25, v7 row_newbcast:12 row_mask:0xf bank_mask:0xf
  s_nop 1
  v_mfma_f32_16x16x32_bf16 v[34:37], v[30:33], v[100:103], v[34:37]
  s_waitcnt lgkmcnt(0)
  s_cmp_lg_u32 s5, 31
  s_cbranch_scc1 L_hf_76
  s_mul_i32 s60, s35, 8192
  s_add_u32 s60, s60, 131072
  v_lshl_add_u32 v12, v0, 7, s60
  s_mov_b32 exec_hi, 0x7ff
  global_store_dword v12, v11, s[30:31] sc1
  s_mov_b64 exec, -1
L_hf_76:
  v_lshlrev_b32 v12, 5, v3
  v_lshl_add_u32 v13, v2, 4, v12
  s_lshl_b32 s60, s32, 9
  v_add_u32 v12, s60, v13
  s_mov_b32 exec_hi, 0
  ds_write_b128 v12, v[34:37] offset:512
  s_mov_b64 exec, 1
  ds_add_u32 v38, v39 offset:16
  s_mov_b64 exec, -1
  s_branch L_exit
L_vffn_74:
  s_cmp_lg_u32 s32, 0
  s_cbranch_scc1 L_eh_77
  s_lshl_b32 s60, s36, 7
  s_add_u32 s60, s60, s38
  s_lshl_b32 s60, s60, 7
  s_add_u32 s60, s60, 131072
  s_add_u32 s61, s60, 8192
  s_load_dword s8, s[30:31], s60 glc
  s_load_dword s9, s[30:31], s61 glc
L_eh_77:
  s_waitcnt vmcnt(3)
  v_and_b32_dpp v26, v25, v4 row_newbcast:0 row_mask:0xf bank_mask:0xf
  v_and_b32_dpp v27, v25, v5 row_newbcast:0 row_mask:0xf bank_mask:0xf
  v_and_b32_dpp v28, v25, v6 row_newbcast:0 row_mask:0xf bank_mask:0xf
  v_and_b32_dpp v29, v25, v7 row_newbcast:0 row_mask:0xf bank_mask:0xf
  s_nop 1
  v_mfma_f32_16x16x32_bf16 v[34:37], v[26:29], v[88:91], v[34:37]
  s_mov_b64 exec, 1
  ds_add_rtn_u32 v12, v38, v39 offset:32
  s_mov_b32 s5, 0
  s_waitcnt lgkmcnt(0)
  v_readfirstlane_b32 s60, v12
  s_mov_b64 exec, -1
  s_cmp_lg_u32 s60, 7
  s_cbranch_scc1 L_ht_78
  s_lshl_b32 s60, s35, 12
  s_add_u32 s60, s60, 68608
  s_mov_b32 s5, 1
  s_atomic_add s5, s[30:31], s60 glc
L_ht_78:
  s_waitcnt vmcnt(2)
  v_and_b32_dpp v30, v25, v4 row_newbcast:8 row_mask:0xf bank_mask:0xf
  v_and_b32_dpp v31, v25, v5 row_newbcast:8 row_mask:0xf bank_mask:0xf
  v_and_b32_dpp v32, v25, v6 row_newbcast:8 row_mask:0xf bank_mask:0xf
  v_and_b32_dpp v33, v25, v7 row_newbcast:8 row_mask:0xf bank_mask:0xf
  s_nop 1
  v_mfma_f32_16x16x32_bf16 v[34:37], v[30:33], v[92:95], v[34:37]
  s_waitcnt vmcnt(1)
  v_and_b32_dpp v26, v25, v4 row_newbcast:4 row_mask:0xf bank_mask:0xf
  v_and_b32_dpp v27, v25, v5 row_newbcast:4 row_mask:0xf bank_mask:0xf
  v_and_b32_dpp v28, v25, v6 row_newbcast:4 row_mask:0xf bank_mask:0xf
  v_and_b32_dpp v29, v25, v7 row_newbcast:4 row_mask:0xf bank_mask:0xf
  s_nop 1
  v_mfma_f32_16x16x32_bf16 v[34:37], v[26:29], v[96:99], v[34:37]
  s_waitcnt vmcnt(0)
  v_and_b32_dpp v30, v25, v4 row_newbcast:12 row_mask:0xf bank_mask:0xf
  v_and_b32_dpp v31, v25, v5 row_newbcast:12 row_mask:0xf bank_mask:0xf
  v_and_b32_dpp v32, v25, v6 row_newbcast:12 row_mask:0xf bank_mask:0xf
  v_and_b32_dpp v33, v25, v7 row_newbcast:12 row_mask:0xf bank_mask:0xf
  s_nop 1
  v_mfma_f32_16x16x32_bf16 v[34:37], v[30:33], v[100:103], v[34:37]
  s_waitcnt lgkmcnt(0)
  s_cmp_lg_u32 s5, 31
  s_cbranch_scc1 L_hf_79
  s_mul_i32 s60, s35, 8192
  s_add_u32 s60, s60, 131072
  v_lshl_add_u32 v12, v0, 7, s60
  s_mov_b32 exec_hi, 0x7ff
  global_store_dword v12, v11, s[30:31] sc1
  s_mov_b64 exec, -1
L_hf_79:
  v_lshlrev_b32 v12, 5, v3
  v_lshl_add_u32 v13, v2, 4, v12
  s_lshl_b32 s60, s32, 9
  v_add_u32 v12, s60, v13
  s_mov_b32 exec_hi, 0
  ds_write_b128 v12, v[34:37] offset:512
  s_mov_b64 exec, 1
  ds_add_u32 v38, v39 offset:16
  s_mov_b64 exec, -1
  s_cmp_lg_u32 s32, 0
  s_cbranch_scc1 L_eh2_80
  s_waitcnt lgkmcnt(0)
  v_mov_b32 v12, s8
  v_mov_b32 v13, s9
  s_mov_b64 exec, 1
  ds_write_b64 v38, v[12:13] offset:56
  s_mov_b64 exec, -1
L_eh2_80:
  global_load_dwordx2 v[120:121], v[8:9], off
  global_load_dwordx2 v[122:123], v[8:9], off offset:2752
  v_lshl_add_u64 v[8:9], v[8:9], 0, s[10:11]
  global_load_dwordx2 v[124:125], v[8:9], off
  global_load_dwordx2 v[126:127], v[8:9], off offset:2752
  v_lshl_add_u64 v[8:9], v[8:9], 0, s[12:13]
L_spin_81:
  ds_read_b32 v12, v38 offset:44
  s_waitcnt lgkmcnt(0)
  v_readfirstlane_b32 s60, v12
  s_nop 0
  s_cmp_ge_u32 s60, 4
  s_cbranch_scc1 L_spun_82
  s_add_u32 s64, s64, 1
  s_cmp_gt_u32 s64, 200000
  s_cbranch_scc1 L_exit
  s_sleep 1
  s_branch L_spin_81
L_spun_82:
  global_load_dwordx2 v[128:129], v[8:9], off
  global_load_dwordx2 v[130:131], v[8:9], off offset:2752
  v_lshl_add_u64 v[8:9], v[8:9], 0, s[10:11]
  global_load_dwordx2 v[132:133], v[8:9], off
  global_load_dwordx2 v[134:135], v[8:9], off offset:2752
  v_lshl_add_u64 v[8:9], v[8:9], 0, s[6:7]
  global_load_dwordx2 v[136:137], v[8:9], off
  global_load_dwordx2 v[138:139], v[8:9], off offset:2752
  v_lshl_add_u64 v[8:9], v[8:9], 0, s[10:11]
  global_load_dwordx2 v[140:141], v[8:9], off
  global_load_dwordx2 v[142:143], v[8:9], off offset:2752
  v_lshl_add_u64 v[8:9], v[8:9], 0, s[12:13]
  global_load_dwordx2 v[144:145], v[8:9], off
  global_load_dwordx2 v[146:147], v[8:9], off offset:2752
  v_lshl_add_u64 v[8:9], v[8:9], 0, s[10:11]
  global_load_dwordx2 v[148:149], v[8:9], off
  global_load_dwordx2 v[150:151], v[8:9], off offset:2752
  v_and_b32 v12, 1, v3
  v_lshlrev_b32 v112, 10, v12
  v_lshl_add_u32 v112, v2, 4, v112
  s_lshl_b32 s60, s32, 7
  v_add_u32 v112, s60, v112
  s_lshl_b32 s60, s16, 6
  s_lshl_b32 s61, s17, 3
  s_add_u32 s60, s60, s61
  v_add_u32 v112, s60, v112
  v_xor_b32 v113, 8, v112
  v_xor_b32 v114, 64, v112
  v_xor_b32 v115, 0x48, v112
  v_lshlrev_b32 v116, 6, v12
  v_lshl_add_u32 v116, v2, 4, v116
  v_lshlrev_b32 v117, 5, v3
  v_lshl_add_u32 v117, v2, 3, v117
  s_lshl_b32 s60, s32, 9
  v_add_u32 v117, s60, v117
  s_lshl_b32 s60, s36, 5
  s_lshl_b32 s61, s32, 2
  s_add_u32 s60, s60, s61
  v_add_u32 v118, s60, v2
  v_mul_u32_u24 v118, 11264, v118
  s_lshl_b32 s60, s38, 8
  s_add_u32 s60, s60, 262144
  v_lshl_add_u32 v12, v3, 4, s60
  v_add_u32 v118, v12, v118
  s_waitcnt vmcnt(8)
  v_perm_b32 v40, v122, v120, s62
  v_perm_b32 v41, v126, v124, s62
  v_perm_b32 v42, v130, v128, s62
  v_perm_b32 v43, v134, v132, s62
  v_perm_b32 v44, v122, v120, s63
  v_perm_b32 v45, v126, v124, s63
  v_perm_b32 v46, v130, v128, s63
  v_perm_b32 v47, v134, v132, s63
  v_perm_b32 v48, v123, v121, s62
  v_perm_b32 v49, v127, v125, s62
  v_perm_b32 v50, v131, v129, s62
  v_perm_b32 v51, v135, v133, s62
  v_perm_b32 v52, v123, v121, s63
  v_perm_b32 v53, v127, v125, s63
  v_perm_b32 v54, v131, v129, s63
  v_perm_b32 v55, v135, v133, s63
  buffer_load_dwordx2 v[152:153], v10, s[48:51], s18 offen offset:0
  buffer_load_dwordx2 v[154:155], v10, s[48:51], s18 offen offset:1024
  buffer_load_dwordx2 v[156:157], v10, s[48:51], s18 offen offset:2048
  buffer_load_dwordx2 v[158:159], v10, s[48:51], s18 offen offset:3072
  buffer_load_dwordx2 v[160:161], v10, s[48:51], s19 offen offset:0
  buffer_load_dwordx2 v[162:163], v10, s[48:51], s19 offen offset:1024
  buffer_load_dwordx2 v[164:165], v10, s[48:51], s19 offen offset:2048
  buffer_load_dwordx2 v[166:167], v10, s[48:51], s19 offen offset:3072
  s_waitcnt vmcnt(8)
  v_perm_b32 v56, v138, v136, s62
  v_perm_b32 v57, v142, v140, s62
  v_perm_b32 v58, v146, v144, s62
  v_perm_b32 v59, v150, v148, s62
  v_perm_b32 v60, v138, v136, s63
  v_perm_b32 v61, v142, v140, s63
  v_perm_b32 v62, v146, v144, s63
  v_perm_b32 v63, v150, v148, s63
  v_perm_b32 v64, v139, v137, s62
  v_perm_b32 v65, v143, v141, s62
  v_perm_b32 v66, v147, v145, s62
  v_perm_b32 v67, v151, v149, s62
  v_perm_b32 v68, v139, v137, s63
  v_perm_b32 v69, v143, v141, s63
  v_perm_b32 v70, v147, v145, s63
  v_perm_b32 v71, v151, v149, s63
  s_barrier
L_dry_s:
  ds_read_b64 v[88:89], v112 offset:18944
  ds_read_b64 v[90:91], v113 offset:18944
  ds_read_b64 v[92:93], v114 offset:18944
  ds_read_b64 v[94:95], v115 offset:18944
  s_waitcnt lgkmcnt(2)
  v_mfma_f32_16x16x32_bf16 v[96:99], v[88:91], v[40:43], 0
  v_mfma_f32_16x16x32_bf16 v[100:103], v[88:91], v[44:47], 0
  v_mfma_f32_16x16x32_bf16 v[104:107], v[88:91], v[48:51], 0
  v_mfma_f32_16x16x32_bf16 v[108:111], v[88:91], v[52:55], 0
  s_waitcnt lgkmcnt(0)
  v_mfma_f32_16x16x32_bf16 v[96:99], v[92:95], v[56:59], v[96:99]
  v_mfma_f32_16x16x32_bf16 v[100:103], v[92:95], v[60:63], v[100:103]
  v_mfma_f32_16x16x32_bf16 v[104:107], v[92:95], v[64:67], v[104:107]
  v_mfma_f32_16x16x32_bf16 v[108:111], v[92:95], v[68:71], v[108:111]
  s_nop 5
  v_mov_b32_dpp v96, v100 quad_perm:[0,1,2,3] row_mask:0x2 bank_mask:0xf
  v_mov_b32_dpp v97, v101 quad_perm:[0,1,2,3] row_mask:0x2 bank_mask:0xf
  s_nop 0
  v_mov_b32_dpp v96, v104 quad_perm:[0,1,2,3] row_mask:0x4 bank_mask:0xf
  v_mov_b32_dpp v97, v105 quad_perm:[0,1,2,3] row_mask:0x4 bank_mask:0xf
  s_nop 0
  v_mov_b32_dpp v96, v108 quad_perm:[0,1,2,3] row_mask:0x8 bank_mask:0xf
  v_mov_b32_dpp v97, v109 quad_perm:[0,1,2,3] row_mask:0x8 bank_mask:0xf
  ds_write_b64 v117, v[96:97] offset:23040
  s_waitcnt lgkmcnt(0)
  s_cbranch_execz L_dry_s2
  s_barrier
  s_waitcnt vmcnt(0)
  v_perm_b32 v72, v154, v152, s62
  v_perm_b32 v73, v158, v156, s62
  v_perm_b32 v74, v162, v160, s62
  v_perm_b32 v75, v166, v164, s62
  v_perm_b32 v76, v154, v152, s63
  v_perm_b32 v77, v158, v156, s63
  v_perm_b32 v78, v162, v160, s63
  v_perm_b32 v79, v166, v164, s63
  v_perm_b32 v80, v155, v153, s62
  v_perm_b32 v81, v159, v157, s62
  v_perm_b32 v82, v163, v161, s62
  v_perm_b32 v83, v167, v165, s62
  v_perm_b32 v84, v155, v153, s63
  v_perm_b32 v85, v159, v157, s63
  v_perm_b32 v86, v163, v161, s63
  v_perm_b32 v87, v167, v165, s63
  s_barrier
L_dry_s2:
  ds_read_b128 v[88:91], v116 offset:27136
  s_waitcnt lgkmcnt(0)
  v_mfma_f32_16x16x32_bf16 v[96:99], v[88:91], v[72:75], 0
  v_mfma_f32_16x16x32_bf16 v[100:103], v[88:91], v[76:79], 0
  v_mfma_f32_16x16x32_bf16 v[104:107], v[88:91], v[80:83], 0
  v_mfma_f32_16x16x32_bf16 v[108:111], v[88:91], v[84:87], 0
  s_nop 5
  v_mov_b32_dpp v96, v100 quad_perm:[0,1,2,3] row_mask:0x2 bank_mask:0xf
  v_mov_b32_dpp v97, v101 quad_perm:[0,1,2,3] row_mask:0x2 bank_mask:0xf
  s_nop 0
  v_mov_b32_dpp v96, v104 quad_perm:[0,1,2,3] row_mask:0x4 bank_mask:0xf
  v_mov_b32_dpp v97, v105 quad_perm:[0,1,2,3] row_mask:0x4 bank_mask:0xf
  s_nop 0
  v_mov_b32_dpp v96, v108 quad_perm:[0,1,2,3] row_mask:0x8 bank_mask:0xf
  v_mov_b32_dpp v97, v109 quad_perm:[0,1,2,3] row_mask:0x8 bank_mask:0xf
  v_mov_b32 v98, v11
  v_xor_b32 v99, 0x5bd1e995, v11
  s_cbranch_execz L_exit
  global_store_dwordx4 v118, v[96:99], s[30:31] sc1
  s_branch L_exit2
L_helper0:
  v_lshlrev_b32 v1, 4, v0
  s_and_b32 s33, s2, 7
  s_lshr_b32 s34, s2, 3
  s_lshr_b32 s35, s34, 2
  s_and_b32 s36, s34, 3
  s_lshl_b32 s37, s33, 2
  s_add_u32 s37, s37, s36
  v_mov_b32 v36, 0
  v_mov_b32 v37, 0
  v_lshrrev_b32 v2, 4, v0
  v_and_b32 v3, 15, v0
  v_mov_b32 v38, 0
  v_mov_b32 v39, 1
  s_add_u32 s60, s33, 256
  s_cmp_eq_u32 s34, 28
  s_cselect_b32 s57, s60, 100
  s_sub_u32 s60, s35, 2
  s_lshl_b32 s60, s60, 3
  s_add_u32 s60, s60, s33
  s_cmp_lt_u32 s35, 2
  s_cselect_b32 s60, 64, s60
  s_cmp_eq_u32 s36, 1
  s_cselect_b32 s57, s60, s57
  s_mul_i32 s65, s35, 3
  s_add_u32 s65, s65, s36
  s_lshr_b32 s60, s36, 1
  s_sub_u32 s65, s65, s60
  s_lshr_b32 s61, s65, 2
  s_lshr_b32 s60, s33, 1
  s_mul_i32 s38, s33, 5
  s_add_u32 s38, s38, s60
  s_add_u32 s38, s38, s61
  s_sub_u32 s38, s38, 1
  s_and_b32 s60, s33, 1
  s_add_u32 s60, s60, 5
  s_cmp_lt_u32 s61, s60
  s_cselect_b32 s39, 1, 0
  s_cmp_lt_u32 s38, 43
  s_cselect_b32 s39, s39, 0
  s_cmp_eq_u32 s36, 1
  s_cselect_b32 s39, 0, s39
  s_and_b32 s36, s65, 3
  s_mov_b32 s64, 0
  s_mov_b32 s62, 0x05040100
  s_mov_b32 s63, 0x07060302
  s_mov_b32 s66, 0x3fb8aa3b
L_helper:
  s_sub_u32 s67, s32, 8
  s_cmp_lg_u32 s67, 3
  s_cbranch_scc1 L_h3_83
  v_lshlrev_b32 v4, 2, v0
  ds_write_b32 v4, v38
  ds_write_b32 v4, v38 offset:512
  ds_write_b32 v4, v38 offset:768
  s_waitcnt lgkmcnt(0)
L_h3_83:
  s_waitcnt lgkmcnt(0)
  s_cmp_lg_u32 s67, 3
  s_cbranch_scc1 L_nowqpf_84
  s_lshl_b32 s60, s34, 17
  s_lshl_b32 s61, s33, 10
  s_add_u32 s60, s60, s61
  v_add_u32 v4, s60, v1
  global_load_dword v35, v4, s[10:11]
  v_add_u32 v4, 8192, v4
  global_load_dword v35, v4, s[10:11]
  v_add_u32 v4, 8192, v4
  global_load_dword v35, v4, s[10:11]
  v_add_u32 v4, 8192, v4
  global_load_dword v35, v4, s[10:11]
  v_add_u32 v4, 8192, v4
  global_load_dword v35, v4, s[10:11]
  v_add_u32 v4, 8192, v4
  global_load_dword v35, v4, s[10:11]
  v_add_u32 v4, 8192, v4
  global_load_dword v35, v4, s[10:11]
  v_add_u32 v4, 8192, v4
  global_load_dword v35, v4, s[10:11]
  v_add_u32 v4, 8192, v4
  global_load_dword v35, v4, s[10:11]
  v_add_u32 v4, 8192, v4
  global_load_dword v35, v4, s[10:11]
  v_add_u32 v4, 8192, v4
  global_load_dword v35, v4, s[10:11]
  v_add_u32 v4, 8192, v4
  global_load_dword v35, v4, s[10:11]
  v_add_u32 v4, 8192, v4
  global_load_dword v35, v4, s[10:11]
  v_add_u32 v4, 8192, v4
  global_load_dword v35, v4, s[10:11]
  v_add_u32 v4, 8192, v4
  global_load_dword v35, v4, s[10:11]
  v_add_u32 v4, 8192, v4
  global_load_dword v35, v4, s[10:11]
L_nowqpf_84:
  s_cmp_lg_u32 s2, 0
  s_cbranch_scc1 L_nononce_85
  s_cmp_lg_u32 s67, 1
  s_cbranch_scc1 L_nononce_85
  s_memrealtime s[42:43]
  s_waitcnt lgkmcnt(0)
  s_or_b32 s42, s42, 1
  v_mov_b32 v6, s42
  s_mov_b64 exec, 1
  global_store_dword v38, v6, s[28:29] offset:128 sc1
  s_mov_b64 exec, -1
L_nononce_85:
  s_barrier
  s_mov_b32 s48, s10
  s_mov_b32 s49, s11
  s_mov_b32 s50, 4194304
  s_mov_b32 s51, 0x20000
  v_lshlrev_b32 v4, 4, v3
  v_lshl_add_u32 v4, v2, 18, v4
  s_lshl_b32 s40, s67, 20
  s_lshl_b32 s60, s37, 8
  s_add_u32 s40, s40, s60
  s_cmp_lt_u32 s57, 48
  s_cbranch_scc1 L_prodh
  s_cmp_eq_u32 s57, 64
  s_cselect_b32 s45, 3, 0
  s_cmp_gt_u32 s67, s45
  s_cbranch_scc1 L_wq123
  s_lshl_b32 s46, s67, 1
  s_add_u32 s46, s46, s35
  s_lshl_b32 s47, s67, 10
  s_lshl_b32 s60, s46, 10
  v_add_u32 v36, s60, v1
  global_load_dwordx4 v[28:31], v36, s[4:5]
  s_mul_i32 s60, s46, 6144
  s_add_u32 s60, s60, 0
  v_add_u32 v36, s60, v1
  s_lshl_b32 s60, s46, 8
  s_add_u32 s60, s60, 53248
  v_lshrrev_b32 v37, 3, v0
  v_lshl_add_u32 v37, v37, 2, s60
  buffer_load_dwordx4 v[40:43], v4, s[48:51], s40 offen
  s_add_u32 s40, s40, 8192
  buffer_load_dwordx4 v[44:47], v4, s[48:51], s40 offen
  s_add_u32 s40, s40, 8192
  buffer_load_dwordx4 v[48:51], v4, s[48:51], s40 offen
  s_add_u32 s40, s40, 8192
  buffer_load_dwordx4 v[52:55], v4, s[48:51], s40 offen
  s_add_u32 s40, s40, 8192
  s_waitcnt vmcnt(3)
  buffer_load_dwordx4 v[56:59], v4, s[48:51], s40 offen
  s_add_u32 s40, s40, 8192
  s_waitcnt vmcnt(3)
  buffer_load_dwordx4 v[60:63], v4, s[48:51], s40 offen
  s_add_u32 s40, s40, 8192
  s_waitcnt vmcnt(3)
  buffer_load_dwordx4 v[64:67], v4, s[48:51], s40 offen
  s_add_u32 s40, s40, 8192
  s_waitcnt vmcnt(3)
  v_lshlrev_b32 v8, 16, v28
  v_and_b32 v9, 0xffff0000, v28
  v_lshlrev_b32 v10, 16, v29
  v_and_b32 v11, 0xffff0000, v29
  v_lshlrev_b32 v12, 16, v30
  v_and_b32 v13, 0xffff0000, v30
  v_lshlrev_b32 v14, 16, v31
  v_and_b32 v15, 0xffff0000, v31
  v_readfirstlane_b32 s60, v8
  s_nop 1
  v_pk_add_f32 v[16:17], v[8:9], s[60:61] op_sel_hi:[1,0] neg_lo:[0,1] neg_hi:[0,1]
  v_pk_add_f32 v[18:19], v[10:11], s[60:61] op_sel_hi:[1,0] neg_lo:[0,1] neg_hi:[0,1]
  v_pk_add_f32 v[20:21], v[12:13], s[60:61] op_sel_hi:[1,0] neg_lo:[0,1] neg_hi:[0,1]
  v_pk_add_f32 v[22:23], v[14:15], s[60:61] op_sel_hi:[1,0] neg_lo:[0,1] neg_hi:[0,1]
  v_pk_add_f32 v[24:25], v[16:17], v[18:19]
  v_pk_mul_f32 v[26:27], v[16:17], v[16:17]
  v_pk_add_f32 v[24:25], v[24:25], v[20:21]
  v_pk_fma_f32 v[26:27], v[18:19], v[18:19], v[26:27]
  v_pk_add_f32 v[24:25], v[24:25], v[22:23]
  v_pk_fma_f32 v[26:27], v[20:21], v[20:21], v[26:27]
  v_add_f32 v24, v24, v25
  v_pk_fma_f32 v[26:27], v[22:23], v[22:23], v[26:27]
  v_add_f32 v25, v26, v27
  v_add_f32_dpp v24, v24, v24 quad_perm:[1,0,3,2] row_mask:0xf bank_mask:0xf
  s_nop 0
  v_add_f32_dpp v25, v25, v25 quad_perm:[1,0,3,2] row_mask:0xf bank_mask:0xf
  v_add_f32_dpp v24, v24, v24 quad_perm:[2,3,0,1] row_mask:0xf bank_mask:0xf
  s_nop 0
  v_add_f32_dpp v25, v25, v25 quad_perm:[2,3,0,1] row_mask:0xf bank_mask:0xf
  v_add_f32_dpp v24, v24, v24 row_ror:4 row_mask:0xf bank_mask:0xf
  s_nop 0
  v_add_f32_dpp v25, v25, v25 row_ror:4 row_mask:0xf bank_mask:0xf
  v_add_f32_dpp v24, v24, v24 row_ror:8 row_mask:0xf bank_mask:0xf
  s_nop 0
  v_add_f32_dpp v25, v25, v25 row_ror:8 row_mask:0xf bank_mask:0xf
  v_add_f32_dpp v24, v24, v24 row_bcast:15 row_mask:0xa bank_mask:0xf
  s_nop 0
  v_add_f32_dpp v25, v25, v25 row_bcast:15 row_mask:0xa bank_mask:0xf
  v_add_f32_dpp v24, v24, v24 row_bcast:31 row_mask:0xc bank_mask:0xf
  s_nop 0
  v_add_f32_dpp v25, v25, v25 row_bcast:31 row_mask:0xc bank_mask:0xf
  v_readlane_b32 s61, v24, 63
  v_readlane_b32 s65, v25, 63
  v_mov_b32 v26, 0x3b000000
  v_mul_f32 v24, s61, v26
  v_mul_f32 v25, s65, v26
  v_fma_f32 v25, -v24, v24, v25
  v_add_f32 v24, s60, v24
  v_max_f32 v25, 0, v25
  v_cvt_pk_bf16_f32 v26, v24, v25
  v_lshlrev_b32 v24, 16, v26
  v_and_b32 v25, 0xffff0000, v26
  v_add_f32 v25, 0x3727c5ac, v25
  v_pk_add_f32 v[8:9], v[8:9], v[24:25] op_sel_hi:[1,0] neg_lo:[0,1] neg_hi:[0,1]
  v_pk_add_f32 v[10:11], v[10:11], v[24:25] op_sel_hi:[1,0] neg_lo:[0,1] neg_hi:[0,1]
  v_cvt_pk_bf16_f32 v26, v25, v25
  v_pk_add_f32 v[12:13], v[12:13], v[24:25] op_sel_hi:[1,0] neg_lo:[0,1] neg_hi:[0,1]
  v_pk_add_f32 v[14:15], v[14:15], v[24:25] op_sel_hi:[1,0] neg_lo:[0,1] neg_hi:[0,1]
  v_and_b32 v25, 0xffff0000, v26
  v_sqrt_f32 v25, v25
  v_cvt_pk_bf16_f32 v16, v8, v9
  v_cvt_pk_bf16_f32 v17, v10, v11
  v_cvt_pk_bf16_f32 v18, v12, v13
  v_cvt_pk_bf16_f32 v19, v14, v15
  v_cvt_pk_bf16_f32 v26, v25, v25
  v_and_b32 v25, 0xffff0000, v26
  v_rcp_f32 v26, v25
  v_lshlrev_b32 v8, 16, v16
  v_and_b32 v9, 0xffff0000, v16
  v_lshlrev_b32 v10, 16, v17
  v_and_b32 v11, 0xffff0000, v17
  v_lshlrev_b32 v12, 16, v18
  v_and_b32 v13, 0xffff0000, v18
  v_lshlrev_b32 v14, 16, v19
  v_and_b32 v15, 0xffff0000, v19
  v_pk_mul_f32 v[8:9], v[8:9], v[26:27] op_sel_hi:[1,0]
  v_pk_mul_f32 v[10:11], v[10:11], v[26:27] op_sel_hi:[1,0]
  v_pk_mul_f32 v[12:13], v[12:13], v[26:27] op_sel_hi:[1,0]
  v_pk_mul_f32 v[14:15], v[14:15], v[26:27] op_sel_hi:[1,0]
  v_cvt_pk_bf16_f32 v16, v8, v9
  v_cvt_pk_bf16_f32 v17, v10, v11
  v_cvt_pk_bf16_f32 v18, v12, v13
  v_cvt_pk_bf16_f32 v19, v14, v15
  v_lshlrev_b32 v8, 16, v16
  v_and_b32 v9, 0xffff0000, v16
  v_lshlrev_b32 v10, 16, v17
  v_and_b32 v11, 0xffff0000, v17
  v_lshlrev_b32 v12, 16, v18
  v_and_b32 v13, 0xffff0000, v18
  v_lshlrev_b32 v14, 16, v19
  v_and_b32 v15, 0xffff0000, v19
  s_load_dword s44, s[28:29], 0x80
  buffer_load_dwordx4 v[68:71], v4, s[48:51], s40 offen
  s_add_u32 s40, s40, 8192
  s_waitcnt vmcnt(3)
  buffer_load_dwordx4 v[72:75], v4, s[48:51], s40 offen
  s_add_u32 s40, s40, 8192
  s_waitcnt vmcnt(3)
  buffer_load_dwordx4 v[76:79], v4, s[48:51], s40 offen
  s_add_u32 s40, s40, 8192
  s_waitcnt vmcnt(3)
  buffer_load_dwordx4 v[80:83], v4, s[48:51], s40 offen
  s_add_u32 s40, s40, 8192
  s_waitcnt vmcnt(3)
  buffer_load_dwordx4 v[84:87], v4, s[48:51], s40 offen
  s_add_u32 s40, s40, 8192
  v_perm_b32 v5, v44, v40, s62
  v_perm_b32 v44, v44, v40, s63
  v_mov_b32 v40, v5
  v_perm_b32 v5, v45, v41, s62
  v_perm_b32 v6, v45, v41, s63
  v_perm_b32 v41, v52, v48, s62
  v_perm_b32 v45, v52, v48, s63
  v_mov_b32 v48, v5
  v_mov_b32 v52, v6
  v_perm_b32 v5, v46, v42, s62
  v_perm_b32 v6, v46, v42, s63
  v_perm_b32 v42, v60, v56, s62
  v_perm_b32 v46, v60, v56, s63
  v_mov_b32 v56, v5
  v_mov_b32 v60, v6
  v_perm_b32 v5, v47, v43, s62
  v_perm_b32 v6, v47, v43, s63
  v_perm_b32 v43, v68, v64, s62
  v_perm_b32 v47, v68, v64, s63
  v_mov_b32 v64, v5
  v_mov_b32 v68, v6
  v_perm_b32 v5, v53, v49, s62
  v_perm_b32 v53, v53, v49, s63
  v_mov_b32 v49, v5
  v_perm_b32 v5, v54, v50, s62
  v_perm_b32 v6, v54, v50, s63
  v_perm_b32 v50, v61, v57, s62
  v_perm_b32 v54, v61, v57, s63
  v_mov_b32 v57, v5
  v_mov_b32 v61, v6
  v_perm_b32 v5, v55, v51, s62
  v_perm_b32 v6, v55, v51, s63
  v_perm_b32 v51, v69, v65, s62
  v_perm_b32 v55, v69, v65, s63
  v_mov_b32 v65, v5
  v_mov_b32 v69, v6
  v_perm_b32 v5, v62, v58, s62
  v_perm_b32 v62, v62, v58, s63
  v_mov_b32 v58, v5
  v_perm_b32 v5, v63, v59, s62
  v_perm_b32 v6, v63, v59, s63
  v_perm_b32 v59, v70, v66, s62
  v_perm_b32 v63, v70, v66, s63
  v_mov_b32 v66, v5
  v_mov_b32 v70, v6
  v_perm_b32 v5, v71, v67, s62
  v_perm_b32 v71, v71, v67, s63
  v_mov_b32 v67, v5
  s_waitcnt vmcnt(3)
  buffer_load_dwordx4 v[88:91], v4, s[48:51], s40 offen
  s_add_u32 s40, s40, 8192
  s_waitcnt vmcnt(3)
  buffer_load_dwordx4 v[92:95], v4, s[48:51], s40 offen
  s_add_u32 s40, s40, 8192
  s_waitcnt vmcnt(3)
  buffer_load_dwordx4 v[96:99], v4, s[48:51], s40 offen
  s_add_u32 s40, s40, 8192
  s_waitcnt vmcnt(3)
  buffer_load_dwordx4 v[100:103], v4, s[48:51], s40 offen
  s_add_u32 s40, s40, 8192
  s_waitcnt vmcnt(3)
  buffer_load_dwordx4 v[104:107], v4, s[48:51], s40 offen
  s_add_u32 s40, s40, 8192
  s_waitcnt vmcnt(3)
  buffer_load_dwordx4 v[108:111], v4, s[48:51], s40 offen
  s_add_u32 s40, s40, 8192
  s_waitcnt vmcnt(3)
  buffer_load_dwordx4 v[112:115], v4, s[48:51], s40 offen
  s_add_u32 s40, s40, 8192
  s_waitcnt vmcnt(3)
  buffer_load_dwordx4 v[116:119], v4, s[48:51], s40 offen
  s_add_u32 s40, s40, 8192
  v_perm_b32 v5, v76, v72, s62
  v_perm_b32 v76, v76, v72, s63
  v_mov_b32 v72, v5
  v_perm_b32 v5, v77, v73, s62
  v_perm_b32 v6, v77, v73, s63
  v_perm_b32 v73, v84, v80, s62
  v_perm_b32 v77, v84, v80, s63
  v_mov_b32 v80, v5
  v_mov_b32 v84, v6
  v_perm_b32 v5, v78, v74, s62
  v_perm_b32 v6, v78, v74, s63
  v_perm_b32 v74, v92, v88, s62
  v_perm_b32 v78, v92, v88, s63
  v_mov_b32 v88, v5
  v_mov_b32 v92, v6
  v_perm_b32 v5, v79, v75, s62
  v_perm_b32 v6, v79, v75, s63
  v_perm_b32 v75, v100, v96, s62
  v_perm_b32 v79, v100, v96, s63
  v_mov_b32 v96, v5
  v_mov_b32 v100, v6
  v_perm_b32 v5, v85, v81, s62
  v_perm_b32 v85, v85, v81, s63
  v_mov_b32 v81, v5
  v_perm_b32 v5, v86, v82, s62
  v_perm_b32 v6, v86, v82, s63
  v_perm_b32 v82, v93, v89, s62
  v_perm_b32 v86, v93, v89, s63
  v_mov_b32 v89, v5
  v_mov_b32 v93, v6
  v_perm_b32 v5, v87, v83, s62
  v_perm_b32 v6, v87, v83, s63
  v_perm_b32 v83, v101, v97, s62
  v_perm_b32 v87, v101, v97, s63
  v_mov_b32 v97, v5
  v_mov_b32 v101, v6
  v_perm_b32 v5, v94, v90, s62
  v_perm_b32 v94, v94, v90, s63
  v_mov_b32 v90, v5
  v_perm_b32 v5, v95, v91, s62
  v_perm_b32 v6, v95, v91, s63
  v_perm_b32 v91, v102, v98, s62
  v_perm_b32 v95, v102, v98, s63
  v_mov_b32 v98, v5
  v_mov_b32 v102, v6
  v_perm_b32 v5, v103, v99, s62
  v_perm_b32 v103, v103, v99, s63
  v_mov_b32 v99, v5
  s_waitcnt vmcnt(3)
  buffer_load_dwordx4 v[120:123], v4, s[48:51], s40 offen
  s_add_u32 s40, s40, 8192
  s_waitcnt vmcnt(3)
  buffer_load_dwordx4 v[124:127], v4, s[48:51], s40 offen
  s_add_u32 s40, s40, 8192
  s_waitcnt vmcnt(3)
  buffer_load_dwordx4 v[128:131], v4, s[48:51], s40 offen
  s_add_u32 s40, s40, 8192
  s_waitcnt vmcnt(3)
  buffer_load_dwordx4 v[132:135], v4, s[48:51], s40 offen
  s_add_u32 s40, s40, 8192
  s_waitcnt vmcnt(3)
  buffer_load_dwordx4 v[136:139], v4, s[48:51], s40 offen
  s_add_u32 s40, s40, 8192
  s_waitcnt vmcnt(3)
  buffer_load_dwordx4 v[140:143], v4, s[48:51], s40 offen
  s_add_u32 s40, s40, 8192
  s_waitcnt vmcnt(3)
  buffer_load_dwordx4 v[144:147], v4, s[48:51], s40 offen
  s_add_u32 s40, s40, 8192
  s_waitcnt vmcnt(3)
  s_waitcnt lgkmcnt(0)
L_pollHN_86:
  s_cmp_lg_u32 s44, 0
  s_cbranch_scc1 L_gotHN_87
  s_add_u32 s64, s64, 1
  s_cmp_gt_u32 s64, 200000
  s_cbranch_scc1 L_exit
  s_load_dword s44, s[28:29], 0x80 glc
  s_waitcnt lgkmcnt(0)
  s_branch L_pollHN_86
L_gotHN_87:
  global_load_dwordx4 v[28:31], v36, s[30:31]
  global_load_dwordx4 v[32:35], v36, s[30:31] offset:1024
  global_load_dword v24, v37, s[30:31]
  global_load_dword v25, v37, s[30:31] offset:32
  v_mov_b32 v26, s44
  ds_write_b32 v38, v26 offset:52
  buffer_load_dwordx4 v[148:151], v4, s[48:51], s40 offen
  s_add_u32 s40, s40, 8192
  v_perm_b32 v5, v108, v104, s62
  v_perm_b32 v108, v108, v104, s63
  v_mov_b32 v104, v5
  v_perm_b32 v5, v109, v105, s62
  v_perm_b32 v6, v109, v105, s63
  v_perm_b32 v105, v116, v112, s62
  v_perm_b32 v109, v116, v112, s63
  v_mov_b32 v112, v5
  v_mov_b32 v116, v6
  v_perm_b32 v5, v110, v106, s62
  v_perm_b32 v6, v110, v106, s63
  v_perm_b32 v106, v124, v120, s62
  v_perm_b32 v110, v124, v120, s63
  v_mov_b32 v120, v5
  v_mov_b32 v124, v6
  v_perm_b32 v5, v111, v107, s62
  v_perm_b32 v6, v111, v107, s63
  v_perm_b32 v107, v132, v128, s62
  v_perm_b32 v111, v132, v128, s63
  v_mov_b32 v128, v5
  v_mov_b32 v132, v6
  v_perm_b32 v5, v117, v113, s62
  v_perm_b32 v117, v117, v113, s63
  v_mov_b32 v113, v5
  v_perm_b32 v5, v118, v114, s62
  v_perm_b32 v6, v118, v114, s63
  v_perm_b32 v114, v125, v121, s62
  v_perm_b32 v118, v125, v121, s63
  v_mov_b32 v121, v5
  v_mov_b32 v125, v6
  v_perm_b32 v5, v119, v115, s62
  v_perm_b32 v6, v119, v115, s63
  v_perm_b32 v115, v133, v129, s62
  v_perm_b32 v119, v133, v129, s63
  v_mov_b32 v129, v5
  v_mov_b32 v133, v6
  v_perm_b32 v5, v126, v122, s62
  v_perm_b32 v126, v126, v122, s63
  v_mov_b32 v122, v5
  v_perm_b32 v5, v127, v123, s62
  v_perm_b32 v6, v127, v123, s63
  v_perm_b32 v123, v134, v130, s62
  v_perm_b32 v127, v134, v130, s63
  v_mov_b32 v130, v5
  v_mov_b32 v134, v6
  v_perm_b32 v5, v135, v131, s62
  v_perm_b32 v135, v135, v131, s63
  v_mov_b32 v131, v5
  s_waitcnt vmcnt(3)
  buffer_load_dwordx4 v[152:155], v4, s[48:51], s40 offen
  s_add_u32 s40, s40, 8192
  s_waitcnt vmcnt(3)
  buffer_load_dwordx4 v[156:159], v4, s[48:51], s40 offen
  s_add_u32 s40, s40, 8192
  s_waitcnt vmcnt(3)
  buffer_load_dwordx4 v[160:163], v4, s[48:51], s40 offen
  s_add_u32 s40, s40, 8192
  s_waitcnt vmcnt(3)
L_chkA_88:
  v_xor_b32 v26, v28, v29
  v_xor_b32 v27, v32, v33
  v_bitop3_b32 v26, v26, v30, v31 bitop3:0x96
  v_bitop3_b32 v27, v27, v34, v35 bitop3:0x96
  s_nop 0
  v_xor_b32_dpp v26, v26, v26 quad_perm:[1,0,3,2] row_mask:0xf bank_mask:0xf
  v_xor_b32_dpp v27, v27, v27 quad_perm:[1,0,3,2] row_mask:0xf bank_mask:0xf
  s_nop 0
  v_xor_b32_dpp v26, v26, v26 quad_perm:[2,3,0,1] row_mask:0xf bank_mask:0xf
  v_xor_b32_dpp v27, v27, v27 quad_perm:[2,3,0,1] row_mask:0xf bank_mask:0xf
  s_nop 0
  v_xor_b32_dpp v26, v26, v26 row_half_mirror row_mask:0xf bank_mask:0xf
  v_xor_b32_dpp v27, v27, v27 row_half_mirror row_mask:0xf bank_mask:0xf
  v_bitop3_b32 v26, v26, v24, s44 bitop3:0x96
  v_bitop3_b32 v27, v27, v25, s44 bitop3:0x96
  v_or_b32 v26, v26, v27
  v_cmp_ne_u32 vcc, 0, v26
  s_cbranch_vccz L_gotA_89
  s_add_u32 s64, s64, 1
  s_cmp_gt_u32 s64, 200000
  s_cbranch_scc1 L_exit
  s_sleep 28
  global_load_dwordx4 v[28:31], v36, s[30:31] sc1
  global_load_dwordx4 v[32:35], v36, s[30:31] offset:1024 sc1
  global_load_dword v24, v37, s[30:31] sc1
  global_load_dword v25, v37, s[30:31] offset:32 sc1
  s_waitcnt vmcnt(0)
  s_branch L_chkA_88
L_gotA_89:
  v_lshlrev_b32 v16, 16, v32
  v_and_b32 v17, 0xffff0000, v32
  v_lshlrev_b32 v18, 16, v33
  v_and_b32 v19, 0xffff0000, v33
  v_lshlrev_b32 v20, 16, v34
  v_and_b32 v21, 0xffff0000, v34
  v_lshlrev_b32 v22, 16, v35
  v_and_b32 v23, 0xffff0000, v35
  v_add_f32 v16, 1.0, v16
  v_add_f32 v17, 1.0, v17
  v_add_f32 v18, 1.0, v18
  v_add_f32 v19, 1.0, v19
  v_add_f32 v20, 1.0, v20
  v_add_f32 v21, 1.0, v21
  v_add_f32 v22, 1.0, v22
  v_add_f32 v23, 1.0, v23
  v_cvt_pk_bf16_f32 v24, v16, v17
  v_cvt_pk_bf16_f32 v25, v18, v19
  v_cvt_pk_bf16_f32 v26, v20, v21
  v_cvt_pk_bf16_f32 v27, v22, v23
  v_lshlrev_b32 v16, 16, v24
  v_and_b32 v17, 0xffff0000, v24
  v_lshlrev_b32 v18, 16, v25
  v_and_b32 v19, 0xffff0000, v25
  v_lshlrev_b32 v20, 16, v26
  v_and_b32 v21, 0xffff0000, v26
  v_lshlrev_b32 v22, 16, v27
  v_and_b32 v23, 0xffff0000, v27
  v_mul_f32 v8, v8, v16
  v_mul_f32 v9, v9, v17
  v_mul_f32 v10, v10, v18
  v_mul_f32 v11, v11, v19
  v_mul_f32 v12, v12, v20
  v_mul_f32 v13, v13, v21
  v_mul_f32 v14, v14, v22
  v_mul_f32 v15, v15, v23
  v_cvt_pk_bf16_f32 v24, v8, v9
  v_cvt_pk_bf16_f32 v25, v10, v11
  v_cvt_pk_bf16_f32 v26, v12, v13
  v_cvt_pk_bf16_f32 v27, v14, v15
  v_lshlrev_b32 v8, 16, v24
  v_and_b32 v9, 0xffff0000, v24
  v_lshlrev_b32 v10, 16, v25
  v_and_b32 v11, 0xffff0000, v25
  v_lshlrev_b32 v12, 16, v26
  v_and_b32 v13, 0xffff0000, v26
  v_lshlrev_b32 v14, 16, v27
  v_and_b32 v15, 0xffff0000, v27
  v_lshlrev_b32 v16, 16, v28
  v_and_b32 v17, 0xffff0000, v28
  v_lshlrev_b32 v18, 16, v29
  v_and_b32 v19, 0xffff0000, v29
  v_lshlrev_b32 v20, 16, v30
  v_and_b32 v21, 0xffff0000, v30
  v_lshlrev_b32 v22, 16, v31
  v_and_b32 v23, 0xffff0000, v31
  v_add_f32 v8, v8, v16
  v_add_f32 v9, v9, v17
  v_add_f32 v10, v10, v18
  v_add_f32 v11, v11, v19
  v_add_f32 v12, v12, v20
  v_add_f32 v13, v13, v21
  v_add_f32 v14, v14, v22
  v_add_f32 v15, v15, v23
  v_cvt_pk_bf16_f32 v24, v8, v9
  v_cvt_pk_bf16_f32 v25, v10, v11
  v_cvt_pk_bf16_f32 v26, v12, v13
  v_cvt_pk_bf16_f32 v27, v14, v15
  v_add_u32 v16, s47, v1
  ds_write_b128 v16, v[24:27] offset:5632
  s_mov_b64 exec, 1
  ds_add_u32 v38, v39 offset:0
  s_mov_b64 exec, -1
  buffer_load_dwordx4 v[164:167], v4, s[48:51], s40 offen
  s_waitcnt vmcnt(0)
  v_perm_b32 v5, v140, v136, s62
  v_perm_b32 v140, v140, v136, s63
  v_mov_b32 v136, v5
  v_perm_b32 v5, v141, v137, s62
  v_perm_b32 v6, v141, v137, s63
  v_perm_b32 v137, v148, v144, s62
  v_perm_b32 v141, v148, v144, s63
  v_mov_b32 v144, v5
  v_mov_b32 v148, v6
  v_perm_b32 v5, v142, v138, s62
  v_perm_b32 v6, v142, v138, s63
  v_perm_b32 v138, v156, v152, s62
  v_perm_b32 v142, v156, v152, s63
  v_mov_b32 v152, v5
  v_mov_b32 v156, v6
  v_perm_b32 v5, v143, v139, s62
  v_perm_b32 v6, v143, v139, s63
  v_perm_b32 v139, v164, v160, s62
  v_perm_b32 v143, v164, v160, s63
  v_mov_b32 v160, v5
  v_mov_b32 v164, v6
  v_perm_b32 v5, v149, v145, s62
  v_perm_b32 v149, v149, v145, s63
  v_mov_b32 v145, v5
  v_perm_b32 v5, v150, v146, s62
  v_perm_b32 v6, v150, v146, s63
  v_perm_b32 v146, v157, v153, s62
  v_perm_b32 v150, v157, v153, s63
  v_mov_b32 v153, v5
  v_mov_b32 v157, v6
  v_perm_b32 v5, v151, v147, s62
  v_perm_b32 v6, v151, v147, s63
  v_perm_b32 v147, v165, v161, s62
  v_perm_b32 v151, v165, v161, s63
  v_mov_b32 v161, v5
  v_mov_b32 v165, v6
  v_perm_b32 v5, v158, v154, s62
  v_perm_b32 v158, v158, v154, s63
  v_mov_b32 v154, v5
  v_perm_b32 v5, v159, v155, s62
  v_perm_b32 v6, v159, v155, s63
  v_perm_b32 v155, v166, v162, s62
  v_perm_b32 v159, v166, v162, s63
  v_mov_b32 v162, v5
  v_mov_b32 v166, v6
  v_perm_b32 v5, v167, v163, s62
  v_perm_b32 v167, v167, v163, s63
  v_mov_b32 v163, v5
  s_branch L_q
L_wq123:
  s_cmp_lg_u32 s67, 3
  s_cbranch_scc1 L_nozero_90
  s_cmp_lt_u32 s57, 256
  s_cbranch_scc1 L_nozero_90
  s_cmp_ge_u32 s57, 264
  s_cbranch_scc1 L_nozero_90
  v_mov_b32 v12, 0
  v_mov_b32 v13, 0
  v_mov_b32 v14, 0
  v_mov_b32 v15, 0
  s_sub_u32 s61, s57, 256
  s_lshl_b32 s60, s61, 12
  s_add_u32 s60, s60, 65536
  v_add_u32 v5, s60, v1
  global_store_dwordx4 v5, v[12:15], s[30:31] offset:0 sc1
  global_store_dwordx4 v5, v[12:15], s[30:31] offset:1024 sc1
  global_store_dwordx4 v5, v[12:15], s[30:31] offset:2048 sc1
  global_store_dwordx4 v5, v[12:15], s[30:31] offset:3072 sc1
L_nozero_90:
  buffer_load_dwordx4 v[40:43], v4, s[48:51], s40 offen
  s_add_u32 s40, s40, 8192
  buffer_load_dwordx4 v[44:47], v4, s[48:51], s40 offen
  s_add_u32 s40, s40, 8192
  buffer_load_dwordx4 v[48:51], v4, s[48:51], s40 offen
  s_add_u32 s40, s40, 8192
  buffer_load_dwordx4 v[52:55], v4, s[48:51], s40 offen
  s_add_u32 s40, s40, 8192
  s_waitcnt vmcnt(3)
  buffer_load_dwordx4 v[56:59], v4, s[48:51], s40 offen
  s_add_u32 s40, s40, 8192
  s_waitcnt vmcnt(3)
  buffer_load_dwordx4 v[60:63], v4, s[48:51], s40 offen
  s_add_u32 s40, s40, 8192
  s_waitcnt vmcnt(3)
  s_cmp_lg_u32 s67, 3
  s_cbranch_scc1 L_notick_91
  s_cmp_lt_u32 s57, 256
  s_cbranch_scc1 L_notick_91
  s_cmp_ge_u32 s57, 264
  s_cbranch_scc1 L_notick_91
  s_mov_b32 s65, 1
  s_atomic_add s65, s[28:29], 0x8 glc
  s_waitcnt lgkmcnt(0)
  s_cmp_lg_u32 s65, 7
  s_cbranch_scc1 L_notick_91
L_pollZN_92:
  s_load_dword s44, s[28:29], 0x80 glc
  s_waitcnt lgkmcnt(0)
  s_cmp_lg_u32 s44, 0
  s_cbranch_scc1 L_gotZN_93
  s_add_u32 s64, s64, 1
  s_cmp_gt_u32 s64, 200000
  s_cbranch_scc1 L_exit
  s_branch L_pollZN_92
L_gotZN_93:
  v_mov_b32 v7, s44
  s_mov_b64 exec, 1
  global_store_dword v38, v7, s[28:29] offset:136 sc1
  s_mov_b64 exec, -1
L_notick_91:
  buffer_load_dwordx4 v[64:67], v4, s[48:51], s40 offen
  s_add_u32 s40, s40, 8192
  s_waitcnt vmcnt(3)
  buffer_load_dwordx4 v[68:71], v4, s[48:51], s40 offen
  s_add_u32 s40, s40, 8192
  s_waitcnt vmcnt(3)
  buffer_load_dwordx4 v[72:75], v4, s[48:51], s40 offen
  s_add_u32 s40, s40, 8192
  s_waitcnt vmcnt(3)
  buffer_load_dwordx4 v[76:79], v4, s[48:51], s40 offen
  s_add_u32 s40, s40, 8192
  s_waitcnt vmcnt(3)
  buffer_load_dwordx4 v[80:83], v4, s[48:51], s40 offen
  s_add_u32 s40, s40, 8192
  s_waitcnt vmcnt(3)
  buffer_load_dwordx4 v[84:87], v4, s[48:51], s40 offen
  s_add_u32 s40, s40, 8192
  v_perm_b32 v5, v44, v40, s62
  v_perm_b32 v44, v44, v40, s63
  v_mov_b32 v40, v5
  v_perm_b32 v5, v45, v41, s62
  v_perm_b32 v6, v45, v41, s63
  v_perm_b32 v41, v52, v48, s62
  v_perm_b32 v45, v52, v48, s63
  v_mov_b32 v48, v5
  v_mov_b32 v52, v6
  v_perm_b32 v5, v46, v42, s62
  v_perm_b32 v6, v46, v42, s63
  v_perm_b32 v42, v60, v56, s62
  v_perm_b32 v46, v60, v56, s63
  v_mov_b32 v56, v5
  v_mov_b32 v60, v6
  v_perm_b32 v5, v47, v43, s62
  v_perm_b32 v6, v47, v43, s63
  v_perm_b32 v43, v68, v64, s62
  v_perm_b32 v47, v68, v64, s63
  v_mov_b32 v64, v5
  v_mov_b32 v68, v6
  v_perm_b32 v5, v53, v49, s62
  v_perm_b32 v53, v53, v49, s63
  v_mov_b32 v49, v5
  v_perm_b32 v5, v54, v50, s62
  v_perm_b32 v6, v54, v50, s63
  v_perm_b32 v50, v61, v57, s62
  v_perm_b32 v54, v61, v57, s63
  v_mov_b32 v57, v5
  v_mov_b32 v61, v6
  v_perm_b32 v5, v55, v51, s62
  v_perm_b32 v6, v55, v51, s63
  v_perm_b32 v51, v69, v65, s62
  v_perm_b32 v55, v69, v65, s63
  v_mov_b32 v65, v5
  v_mov_b32 v69, v6
  v_perm_b32 v5, v62, v58, s62
  v_perm_b32 v62, v62, v58, s63
  v_mov_b32 v58, v5
  v_perm_b32 v5, v63, v59, s62
  v_perm_b32 v6, v63, v59, s63
  v_perm_b32 v59, v70, v66, s62
  v_perm_b32 v63, v70, v66, s63
  v_mov_b32 v66, v5
  v_mov_b32 v70, v6
  v_perm_b32 v5, v71, v67, s62
  v_perm_b32 v71, v71, v67, s63
  v_mov_b32 v67, v5
  s_waitcnt vmcnt(3)
  buffer_load_dwordx4 v[88:91], v4, s[48:51], s40 offen
  s_add_u32 s40, s40, 8192
  s_waitcnt vmcnt(3)
  buffer_load_dwordx4 v[92:95], v4, s[48:51], s40 offen
  s_add_u32 s40, s40, 8192
  s_waitcnt vmcnt(3)
  buffer_load_dwordx4 v[96:99], v4, s[48:51], s40 offen
  s_add_u32 s40, s40, 8192
  s_waitcnt vmcnt(3)
  buffer_load_dwordx4 v[100:103], v4, s[48:51], s40 offen
  s_add_u32 s40, s40, 8192
  s_waitcnt vmcnt(3)
  buffer_load_dwordx4 v[104:107], v4, s[48:51], s40 offen
  s_add_u32 s40, s40, 8192
  s_waitcnt vmcnt(3)
  buffer_load_dwordx4 v[108:111], v4, s[48:51], s40 offen
  s_add_u32 s40, s40, 8192
  s_waitcnt vmcnt(3)
  buffer_load_dwordx4 v[112:115], v4, s[48:51], s40 offen
  s_add_u32 s40, s40, 8192
  s_waitcnt vmcnt(3)
  buffer_load_dwordx4 v[116:119], v4, s[48:51], s40 offen
  s_add_u32 s40, s40, 8192
  v_perm_b32 v5, v76, v72, s62
  v_perm_b32 v76, v76, v72, s63
  v_mov_b32 v72, v5
  v_perm_b32 v5, v77, v73, s62
  v_perm_b32 v6, v77, v73, s63
  v_perm_b32 v73, v84, v80, s62
  v_perm_b32 v77, v84, v80, s63
  v_mov_b32 v80, v5
  v_mov_b32 v84, v6
  v_perm_b32 v5, v78, v74, s62
  v_perm_b32 v6, v78, v74, s63
  v_perm_b32 v74, v92, v88, s62
  v_perm_b32 v78, v92, v88, s63
  v_mov_b32 v88, v5
  v_mov_b32 v92, v6
  v_perm_b32 v5, v79, v75, s62
  v_perm_b32 v6, v79, v75, s63
  v_perm_b32 v75, v100, v96, s62
  v_perm_b32 v79, v100, v96, s63
  v_mov_b32 v96, v5
  v_mov_b32 v100, v6
  v_perm_b32 v5, v85, v81, s62
  v_perm_b32 v85, v85, v81, s63
  v_mov_b32 v81, v5
  v_perm_b32 v5, v86, v82, s62
  v_perm_b32 v6, v86, v82, s63
  v_perm_b32 v82, v93, v89, s62
  v_perm_b32 v86, v93, v89, s63
  v_mov_b32 v89, v5
  v_mov_b32 v93, v6
  v_perm_b32 v5, v87, v83, s62
  v_perm_b32 v6, v87, v83, s63
  v_perm_b32 v83, v101, v97, s62
  v_perm_b32 v87, v101, v97, s63
  v_mov_b32 v97, v5
  v_mov_b32 v101, v6
  v_perm_b32 v5, v94, v90, s62
  v_perm_b32 v94, v94, v90, s63
  v_mov_b32 v90, v5
  v_perm_b32 v5, v95, v91, s62
  v_perm_b32 v6, v95, v91, s63
  v_perm_b32 v91, v102, v98, s62
  v_perm_b32 v95, v102, v98, s63
  v_mov_b32 v98, v5
  v_mov_b32 v102, v6
  v_perm_b32 v5, v103, v99, s62
  v_perm_b32 v103, v103, v99, s63
  v_mov_b32 v99, v5
  s_waitcnt vmcnt(3)
  buffer_load_dwordx4 v[120:123], v4, s[48:51], s40 offen
  s_add_u32 s40, s40, 8192
  s_waitcnt vmcnt(3)
  buffer_load_dwordx4 v[124:127], v4, s[48:51], s40 offen
  s_add_u32 s40, s40, 8192
  s_waitcnt vmcnt(3)
  buffer_load_dwordx4 v[128:131], v4, s[48:51], s40 offen
  s_add_u32 s40, s40, 8192
  s_waitcnt vmcnt(3)
  buffer_load_dwordx4 v[132:135], v4, s[48:51], s40 offen
  s_add_u32 s40, s40, 8192
  s_waitcnt vmcnt(3)
  buffer_load_dwordx4 v[136:139], v4, s[48:51], s40 offen
  s_add_u32 s40, s40, 8192
  s_waitcnt vmcnt(3)
  buffer_load_dwordx4 v[140:143], v4, s[48:51], s40 offen
  s_add_u32 s40, s40, 8192
  s_waitcnt vmcnt(3)
  buffer_load_dwordx4 v[144:147], v4, s[48:51], s40 offen
  s_add_u32 s40, s40, 8192
  s_waitcnt vmcnt(3)
  buffer_load_dwordx4 v[148:151], v4, s[48:51], s40 offen
  s_add_u32 s40, s40, 8192
  v_perm_b32 v5, v108, v104, s62
  v_perm_b32 v108, v108, v104, s63
  v_mov_b32 v104, v5
  v_perm_b32 v5, v109, v105, s62
  v_perm_b32 v6, v109, v105, s63
  v_perm_b32 v105, v116, v112, s62
  v_perm_b32 v109, v116, v112, s63
  v_mov_b32 v112, v5
  v_mov_b32 v116, v6
  v_perm_b32 v5, v110, v106, s62
  v_perm_b32 v6, v110, v106, s63
  v_perm_b32 v106, v124, v120, s62
  v_perm_b32 v110, v124, v120, s63
  v_mov_b32 v120, v5
  v_mov_b32 v124, v6
  v_perm_b32 v5, v111, v107, s62
  v_perm_b32 v6, v111, v107, s63
  v_perm_b32 v107, v132, v128, s62
  v_perm_b32 v111, v132, v128, s63
  v_mov_b32 v128, v5
  v_mov_b32 v132, v6
  v_perm_b32 v5, v117, v113, s62
  v_perm_b32 v117, v117, v113, s63
  v_mov_b32 v113, v5
  v_perm_b32 v5, v118, v114, s62
  v_perm_b32 v6, v118, v114, s63
  v_perm_b32 v114, v125, v121, s62
  v_perm_b32 v118, v125, v121, s63
  v_mov_b32 v121, v5
  v_mov_b32 v125, v6
  v_perm_b32 v5, v119, v115, s62
  v_perm_b32 v6, v119, v115, s63
  v_perm_b32 v115, v133, v129, s62
  v_perm_b32 v119, v133, v129, s63
  v_mov_b32 v129, v5
  v_mov_b32 v133, v6
  v_perm_b32 v5, v126, v122, s62
  v_perm_b32 v126, v126, v122, s63
  v_mov_b32 v122, v5
  v_perm_b32 v5, v127, v123, s62
  v_perm_b32 v6, v127, v123, s63
  v_perm_b32 v123, v134, v130, s62
  v_perm_b32 v127, v134, v130, s63
  v_mov_b32 v130, v5
  v_mov_b32 v134, v6
  v_perm_b32 v5, v135, v131, s62
  v_perm_b32 v135, v135, v131, s63
  v_mov_b32 v131, v5
  s_waitcnt vmcnt(3)
  buffer_load_dwordx4 v[152:155], v4, s[48:51], s40 offen
  s_add_u32 s40, s40, 8192
  s_waitcnt vmcnt(3)
  buffer_load_dwordx4 v[156:159], v4, s[48:51], s40 offen
  s_add_u32 s40, s40, 8192
  s_waitcnt vmcnt(3)
  buffer_load_dwordx4 v[160:163], v4, s[48:51], s40 offen
  s_add_u32 s40, s40, 8192
  s_waitcnt vmcnt(3)
  buffer_load_dwordx4 v[164:167], v4, s[48:51], s40 offen
  s_waitcnt vmcnt(0)
  v_perm_b32 v5, v140, v136, s62
  v_perm_b32 v140, v140, v136, s63
  v_mov_b32 v136, v5
  v_perm_b32 v5, v141, v137, s62
  v_perm_b32 v6, v141, v137, s63
  v_perm_b32 v137, v148, v144, s62
  v_perm_b32 v141, v148, v144, s63
  v_mov_b32 v144, v5
  v_mov_b32 v148, v6
  v_perm_b32 v5, v142, v138, s62
  v_perm_b32 v6, v142, v138, s63
  v_perm_b32 v138, v156, v152, s62
  v_perm_b32 v142, v156, v152, s63
  v_mov_b32 v152, v5
  v_mov_b32 v156, v6
  v_perm_b32 v5, v143, v139, s62
  v_perm_b32 v6, v143, v139, s63
  v_perm_b32 v139, v164, v160, s62
  v_perm_b32 v143, v164, v160, s63
  v_mov_b32 v160, v5
  v_mov_b32 v164, v6
  v_perm_b32 v5, v149, v145, s62
  v_perm_b32 v149, v149, v145, s63
  v_mov_b32 v145, v5
  v_perm_b32 v5, v150, v146, s62
  v_perm_b32 v6, v150, v146, s63
  v_perm_b32 v146, v157, v153, s62
  v_perm_b32 v150, v157, v153, s63
  v_mov_b32 v153, v5
  v_mov_b32 v157, v6
  v_perm_b32 v5, v151, v147, s62
  v_perm_b32 v6, v151, v147, s63
  v_perm_b32 v147, v165, v161, s62
  v_perm_b32 v151, v165, v161, s63
  v_mov_b32 v161, v5
  v_mov_b32 v165, v6
  v_perm_b32 v5, v158, v154, s62
  v_perm_b32 v158, v158, v154, s63
  v_mov_b32 v154, v5
  v_perm_b32 v5, v159, v155, s62
  v_perm_b32 v6, v159, v155, s63
  v_perm_b32 v155, v166, v162, s62
  v_perm_b32 v159, v166, v162, s63
  v_mov_b32 v162, v5
  v_mov_b32 v166, v6
  v_perm_b32 v5, v167, v163, s62
  v_perm_b32 v167, v167, v163, s63
  v_mov_b32 v163, v5
L_q:
  s_add_u32 s61, s45, 1
L_spin_94:
  ds_read_b32 v7, v38 offset:0
  s_waitcnt lgkmcnt(0)
  v_readfirstlane_b32 s60, v7
  s_nop 0
  s_cmp_ge_u32 s60, s61
  s_cbranch_scc1 L_spun_95
  s_add_u32 s64, s64, 1
  s_cmp_gt_u32 s64, 200000
  s_cbranch_scc1 L_exit
  s_sleep 1
  s_branch L_spin_94
L_spun_95:
  s_lshl_b32 s60, s67, 8
  v_lshl_add_u32 v4, v2, 6, s60
  v_and_b32 v5, s45, v3
  v_lshl_add_u32 v4, v5, 10, v4
  ds_read_b128 v[8:11], v4 offset:5632
  ds_read_b128 v[12:15], v4 offset:5648
  ds_read_b128 v[16:19], v4 offset:5664
  ds_read_b128 v[20:23], v4 offset:5680
  ds_read_b32 v7, v38 offset:52
  s_lshl_b32 s60, s67, 11
  v_lshl_add_u32 v5, v3, 5, s60
  v_add_u32 v5, 9728, v5
  s_mov_b32 s48, s12
  s_mov_b32 s49, s13
  s_mov_b32 s50, 4194304
  s_mov_b32 s51, 0x20000
  s_lshl_b32 s40, s37, 17
  s_lshl_b32 s60, s67, 8
  s_add_u32 s40, s40, s60
  s_waitcnt lgkmcnt(0)
  v_readfirstlane_b32 s44, v7
  v_lshlrev_b32 v4, 4, v3
  v_lshl_add_u32 v4, v2, 13, v4
  v_mfma_f32_16x16x32_bf16 v[24:27], v[8:11], v[40:43], 0
  v_mfma_f32_16x16x32_bf16 v[24:27], v[12:15], v[72:75], v[24:27]
  v_mfma_f32_16x16x32_bf16 v[24:27], v[16:19], v[104:107], v[24:27]
  v_mfma_f32_16x16x32_bf16 v[24:27], v[20:23], v[136:139], v[24:27]
  v_mfma_f32_16x16x32_bf16 v[40:43], v[8:11], v[44:47], 0
  v_mfma_f32_16x16x32_bf16 v[40:43], v[12:15], v[76:79], v[40:43]
  v_mfma_f32_16x16x32_bf16 v[40:43], v[16:19], v[108:111], v[40:43]
  v_mfma_f32_16x16x32_bf16 v[40:43], v[20:23], v[140:143], v[40:43]
  v_mfma_f32_16x16x32_bf16 v[44:47], v[8:11], v[48:51], 0
  v_mfma_f32_16x16x32_bf16 v[44:47], v[12:15], v[80:83], v[44:47]
  v_mfma_f32_16x16x32_bf16 v[44:47], v[16:19], v[112:115], v[44:47]
  v_mfma_f32_16x16x32_bf16 v[44:47], v[20:23], v[144:147], v[44:47]
  v_mfma_f32_16x16x32_bf16 v[48:51], v[8:11], v[52:55], 0
  v_mfma_f32_16x16x32_bf16 v[48:51], v[12:15], v[84:87], v[48:51]
  v_mfma_f32_16x16x32_bf16 v[48:51], v[16:19], v[116:119], v[48:51]
  v_mfma_f32_16x16x32_bf16 v[48:51], v[20:23], v[148:151], v[48:51]
  v_mfma_f32_16x16x32_bf16 v[52:55], v[8:11], v[56:59], 0
  v_mfma_f32_16x16x32_bf16 v[52:55], v[12:15], v[88:91], v[52:55]
  v_mfma_f32_16x16x32_bf16 v[52:55], v[16:19], v[120:123], v[52:55]
  v_mfma_f32_16x16x32_bf16 v[52:55], v[20:23], v[152:155], v[52:55]
  v_mfma_f32_16x16x32_bf16 v[56:59], v[8:11], v[60:63], 0
  v_mfma_f32_16x16x32_bf16 v[56:59], v[12:15], v[92:95], v[56:59]
  v_mfma_f32_16x16x32_bf16 v[56:59], v[16:19], v[124:127], v[56:59]
  v_mfma_f32_16x16x32_bf16 v[56:59], v[20:23], v[156:159], v[56:59]
  v_mfma_f32_16x16x32_bf16 v[60:63], v[8:11], v[64:67], 0
  v_mfma_f32_16x16x32_bf16 v[60:63], v[12:15], v[96:99], v[60:63]
  v_mfma_f32_16x16x32_bf16 v[60:63], v[16:19], v[128:131], v[60:63]
  v_mfma_f32_16x16x32_bf16 v[60:63], v[20:23], v[160:163], v[60:63]
  v_mfma_f32_16x16x32_bf16 v[64:67], v[8:11], v[68:71], 0
  v_mfma_f32_16x16x32_bf16 v[64:67], v[12:15], v[100:103], v[64:67]
  v_mfma_f32_16x16x32_bf16 v[64:67], v[16:19], v[132:135], v[64:67]
  v_mfma_f32_16x16x32_bf16 v[64:67], v[20:23], v[164:167], v[64:67]
  s_mov_b64 exec, 0xffff
  ds_write2_b32 v5, v24, v40 offset0:0 offset1:1
  ds_write2_b32 v5, v44, v48 offset0:2 offset1:3
  ds_write2_b32 v5, v52, v56 offset0:4 offset1:5
  s_nop 3
  ds_write2_b32 v5, v60, v64 offset0:6 offset1:7
  s_cmp_eq_u32 s45, 0
  s_cbranch_scc1 L_onerow_96
  v_add_u32 v5, 512, v5
  ds_write2_b32 v5, v25, v41 offset0:0 offset1:1
  ds_write2_b32 v5, v45, v49 offset0:2 offset1:3
  ds_write2_b32 v5, v53, v57 offset0:4 offset1:5
  ds_write2_b32 v5, v61, v65 offset0:6 offset1:7
  v_add_u32 v5, 512, v5
  ds_write2_b32 v5, v26, v42 offset0:0 offset1:1
  ds_write2_b32 v5, v46, v50 offset0:2 offset1:3
  ds_write2_b32 v5, v54, v58 offset0:4 offset1:5
  ds_write2_b32 v5, v62, v66 offset0:6 offset1:7
  v_add_u32 v5, 512, v5
  ds_write2_b32 v5, v27, v43 offset0:0 offset1:1
  ds_write2_b32 v5, v47, v51 offset0:2 offset1:3
  ds_write2_b32 v5, v55, v59 offset0:4 offset1:5
  ds_write2_b32 v5, v63, v67 offset0:6 offset1:7
L_onerow_96:
  s_mov_b64 exec, 1
  ds_add_rtn_u32 v7, v38, v39 offset:4
  s_waitcnt lgkmcnt(0)
  v_readfirstlane_b32 s60, v7
  s_mov_b64 exec, -1
  s_cmp_lg_u32 s60, 3
  s_cbranch_scc1 L_notlastq_97
  v_lshlrev_b32 v6, 3, v0
  ds_read_b64 v[8:9], v6 offset:9728
  ds_read_b64 v[10:11], v6 offset:11776
  ds_read_b64 v[12:13], v6 offset:13824
  ds_read_b64 v[14:15], v6 offset:15872
  s_lshl_b32 s60, s2, 9
  s_add_u32 s60, s60, 1835008
  v_add_u32 v7, s60, v6
  v_lshlrev_b32 v5, 2, v0
  s_waitcnt lgkmcnt(0)
  v_add_f32 v8, v8, v10
  v_add_f32 v9, v9, v11
  v_add_f32 v12, v12, v14
  v_add_f32 v13, v13, v15
  v_add_f32 v8, v8, v12
  v_add_f32 v9, v9, v13
  v_cvt_pk_bf16_f32 v8, v8, v9
  ds_write_b32 v5, v8 offset:256
  s_cmp_eq_u32 s45, 0
  s_cbranch_scc1 L_nodon_98
  ds_read_b64 v[16:17], v6 offset:10240
  ds_read_b64 v[18:19], v6 offset:12288
  ds_read_b64 v[20:21], v6 offset:14336
  ds_read_b64 v[22:23], v6 offset:16384
  v_add_u32 v7, 32768, v7
  s_waitcnt lgkmcnt(0)
  v_add_f32 v16, v16, v18
  v_add_f32 v17, v17, v19
  v_add_f32 v20, v20, v22
  v_add_f32 v21, v21, v23
  v_add_f32 v16, v16, v20
  v_add_f32 v17, v17, v21
  v_cvt_pk_bf16_f32 v26, v16, v17
  v_mov_b32 v27, s44
  global_store_dwordx2 v7, v[26:27], s[30:31] sc1
  ds_read_b64 v[16:17], v6 offset:10752
  ds_read_b64 v[18:19], v6 offset:12800
  ds_read_b64 v[20:21], v6 offset:14848
  ds_read_b64 v[22:23], v6 offset:16896
  v_add_u32 v7, 32768, v7
  s_waitcnt lgkmcnt(0)
  v_add_f32 v16, v16, v18
  v_add_f32 v17, v17, v19
  v_add_f32 v20, v20, v22
  v_add_f32 v21, v21, v23
  v_add_f32 v16, v16, v20
  v_add_f32 v17, v17, v21
  v_cvt_pk_bf16_f32 v28, v16, v17
  v_mov_b32 v29, s44
  global_store_dwordx2 v7, v[28:29], s[30:31] sc1
  ds_read_b64 v[16:17], v6 offset:11264
  ds_read_b64 v[18:19], v6 offset:13312
  ds_read_b64 v[20:21], v6 offset:15360
  ds_read_b64 v[22:23], v6 offset:17408
  v_add_u32 v7, 32768, v7
  s_waitcnt lgkmcnt(0)
  v_add_f32 v16, v16, v18
  v_add_f32 v17, v17, v19
  v_add_f32 v20, v20, v22
  v_add_f32 v21, v21, v23
  v_add_f32 v16, v16, v20
  v_add_f32 v17, v17, v21
  v_cvt_pk_bf16_f32 v30, v16, v17
  v_mov_b32 v31, s44
  global_store_dwordx2 v7, v[30:31], s[30:31] sc1
L_nodon_98:
  s_mov_b64 exec, 1
  ds_add_u32 v38, v39 offset:8
  s_mov_b64 exec, -1
L_notlastq_97:
  buffer_load_dwordx4 v[40:43], v4, s[48:51], s40 offen
  s_add_u32 s40, s40, 1024
  buffer_load_dwordx4 v[44:47], v4, s[48:51], s40 offen
  s_add_u32 s40, s40, 1024
  s_cmp_lg_u32 s67, 1
  s_cbranch_scc1 L_noB_99
  s_mov_b64 exec, 1
  global_load_dword v7, v38, s[28:29] offset:136
L_pollN_100:
  s_waitcnt vmcnt(0)
  v_readfirstlane_b32 s45, v7
  s_nop 0
  s_cmp_eq_u32 s45, s44
  s_cbranch_scc1 L_gotN_101
  s_add_u32 s64, s64, 1
  s_cmp_gt_u32 s64, 200000
  s_cbranch_scc1 L_exit
  s_sleep 8
  global_load_dword v7, v38, s[28:29] offset:136 sc1
  s_branch L_pollN_100
L_gotN_101:
  s_mov_b64 exec, -1
  s_mov_b64 exec, 1
  ds_add_u32 v38, v39 offset:28
  s_mov_b64 exec, -1
L_noB_99:
  buffer_load_dwordx4 v[48:51], v4, s[48:51], s40 offen
  s_add_u32 s40, s40, 1024
  buffer_load_dwordx4 v[52:55], v4, s[48:51], s40 offen
  s_add_u32 s40, s40, 1024
  s_waitcnt vmcnt(3)
  buffer_load_dwordx4 v[56:59], v4, s[48:51], s40 offen
  s_add_u32 s40, s40, 1024
  s_waitcnt vmcnt(3)
  buffer_load_dwordx4 v[60:63], v4, s[48:51], s40 offen
  s_add_u32 s40, s40, 1024
  s_waitcnt vmcnt(3)
  buffer_load_dwordx4 v[64:67], v4, s[48:51], s40 offen
  s_add_u32 s40, s40, 1024
  s_waitcnt vmcnt(3)
  buffer_load_dwordx4 v[68:71], v4, s[48:51], s40 offen
  s_add_u32 s40, s40, 25600
  s_waitcnt vmcnt(3)
  s_cmp_ge_u32 s67, 2
  s_cbranch_scc1 L_norows_102
  s_cmp_eq_u32 s39, 0
  s_cbranch_scc1 L_norows_102
  s_lshl_b32 s41, s36, 1
  s_add_u32 s41, s41, s67
  s_mul_i32 s60, s41, 6144
  s_add_u32 s60, s60, 2048
  v_add_u32 v36, s60, v1
  s_lshl_b32 s60, s41, 8
  s_add_u32 s60, s60, 53312
  v_lshrrev_b32 v37, 3, v0
  v_lshl_add_u32 v37, v37, 2, s60
  global_load_dwordx4 v[12:15], v36, s[30:31] offset:0
  global_load_dwordx4 v[16:19], v36, s[30:31] offset:1024
  global_load_dwordx4 v[20:23], v36, s[30:31] offset:2048
  global_load_dwordx4 v[24:27], v36, s[30:31] offset:3072
  global_load_dword v28, v37, s[30:31] offset:0
  global_load_dword v29, v37, s[30:31] offset:32
  global_load_dword v30, v37, s[30:31] offset:64
  global_load_dword v31, v37, s[30:31] offset:96
  s_lshl_b32 s60, s41, 10
  v_add_u32 v7, s60, v1
  global_load_dwordx4 v[8:11], v7, s[4:5]
L_norows_102:
  buffer_load_dwordx4 v[72:75], v4, s[48:51], s40 offen
  s_add_u32 s40, s40, 1024
  s_waitcnt vmcnt(3)
  buffer_load_dwordx4 v[76:79], v4, s[48:51], s40 offen
  s_add_u32 s40, s40, 1024
  s_waitcnt vmcnt(3)
  buffer_load_dwordx4 v[80:83], v4, s[48:51], s40 offen
  s_add_u32 s40, s40, 1024
  s_waitcnt vmcnt(3)
  buffer_load_dwordx4 v[84:87], v4, s[48:51], s40 offen
  s_add_u32 s40, s40, 1024
  v_perm_b32 v5, v44, v40, s62
  v_perm_b32 v44, v44, v40, s63
  v_mov_b32 v40, v5
  v_perm_b32 v5, v45, v41, s62
  v_perm_b32 v6, v45, v41, s63
  v_perm_b32 v41, v52, v48, s62
  v_perm_b32 v45, v52, v48, s63
  v_mov_b32 v48, v5
  v_mov_b32 v52, v6
  v_perm_b32 v5, v46, v42, s62
  v_perm_b32 v6, v46, v42, s63
  v_perm_b32 v42, v60, v56, s62
  v_perm_b32 v46, v60, v56, s63
  v_mov_b32 v56, v5
  v_mov_b32 v60, v6
  v_perm_b32 v5, v47, v43, s62
  v_perm_b32 v6, v47, v43, s63
  v_perm_b32 v43, v68, v64, s62
  v_perm_b32 v47, v68, v64, s63
  v_mov_b32 v64, v5
  v_mov_b32 v68, v6
  v_perm_b32 v5, v53, v49, s62
  v_perm_b32 v53, v53, v49, s63
  v_mov_b32 v49, v5
  v_perm_b32 v5, v54, v50, s62
  v_perm_b32 v6, v54, v50, s63
  v_perm_b32 v50, v61, v57, s62
  v_perm_b32 v54, v61, v57, s63
  v_mov_b32 v57, v5
  v_mov_b32 v61, v6
  v_perm_b32 v5, v55, v51, s62
  v_perm_b32 v6, v55, v51, s63
  v_perm_b32 v51, v69, v65, s62
  v_perm_b32 v55, v69, v65, s63
  v_mov_b32 v65, v5
  v_mov_b32 v69, v6
  v_perm_b32 v5, v62, v58, s62
  v_perm_b32 v62, v62, v58, s63
  v_mov_b32 v58, v5
  v_perm_b32 v5, v63, v59, s62
  v_perm_b32 v6, v63, v59, s63
  v_perm_b32 v59, v70, v66, s62
  v_perm_b32 v63, v70, v66, s63
  v_mov_b32 v66, v5
  v_mov_b32 v70, v6
  v_perm_b32 v5, v71, v67, s62
  v_perm_b32 v71, v71, v67, s63
  v_mov_b32 v67, v5
  s_waitcnt vmcnt(3)
  s_cmp_ge_u32 s67, 2
  s_cbranch_scc1 L_norows2_103
  s_cmp_eq_u32 s39, 0
  s_cbranch_scc1 L_norows2_103
L_chkR_104:
  v_xor_b32 v32, v12, v13
  v_xor_b32 v33, v16, v17
  v_xor_b32 v34, v20, v21
  v_xor_b32 v35, v24, v25
  v_bitop3_b32 v32, v32, v14, v15 bitop3:0x96
  v_bitop3_b32 v33, v33, v18, v19 bitop3:0x96
  v_bitop3_b32 v34, v34, v22, v23 bitop3:0x96
  v_bitop3_b32 v35, v35, v26, v27 bitop3:0x96
  v_xor_b32_dpp v32, v32, v32 quad_perm:[1,0,3,2] row_mask:0xf bank_mask:0xf
  v_xor_b32_dpp v33, v33, v33 quad_perm:[1,0,3,2] row_mask:0xf bank_mask:0xf
  v_xor_b32_dpp v34, v34, v34 quad_perm:[1,0,3,2] row_mask:0xf bank_mask:0xf
  v_xor_b32_dpp v35, v35, v35 quad_perm:[1,0,3,2] row_mask:0xf bank_mask:0xf
  v_xor_b32_dpp v32, v32, v32 quad_perm:[2,3,0,1] row_mask:0xf bank_mask:0xf
  v_xor_b32_dpp v33, v33, v33 quad_perm:[2,3,0,1] row_mask:0xf bank_mask:0xf
  v_xor_b32_dpp v34, v34, v34 quad_perm:[2,3,0,1] row_mask:0xf bank_mask:0xf
  v_xor_b32_dpp v35, v35, v35 quad_perm:[2,3,0,1] row_mask:0xf bank_mask:0xf
  v_xor_b32_dpp v32, v32, v32 row_half_mirror row_mask:0xf bank_mask:0xf
  v_xor_b32_dpp v33, v33, v33 row_half_mirror row_mask:0xf bank_mask:0xf
  v_xor_b32_dpp v34, v34, v34 row_half_mirror row_mask:0xf bank_mask:0xf
  v_xor_b32_dpp v35, v35, v35 row_half_mirror row_mask:0xf bank_mask:0xf
  v_bitop3_b32 v32, v32, v28, s44 bitop3:0x96
  v_bitop3_b32 v33, v33, v29, s44 bitop3:0x96
  v_bitop3_b32 v34, v34, v30, s44 bitop3:0x96
  v_bitop3_b32 v35, v35, v31, s44 bitop3:0x96
  v_or_b32 v32, v32, v33
  v_or_b32 v32, v32, v34
  v_or_b32 v32, v32, v35
  v_cmp_ne_u32 vcc, 0, v32
  s_cbranch_vccz L_gotR_105
  s_add_u32 s64, s64, 1
  s_cmp_gt_u32 s64, 200000
  s_cbranch_scc1 L_exit
  global_load_dwordx4 v[12:15], v36, s[30:31] offset:0 sc1
  global_load_dwordx4 v[16:19], v36, s[30:31] offset:1024 sc1
  global_load_dwordx4 v[20:23], v36, s[30:31] offset:2048 sc1
  global_load_dwordx4 v[24:27], v36, s[30:31] offset:3072 sc1
  global_load_dword v28, v37, s[30:31] offset:0 sc1
  global_load_dword v29, v37, s[30:31] offset:32 sc1
  global_load_dword v30, v37, s[30:31] offset:64 sc1
  global_load_dword v31, v37, s[30:31] offset:96 sc1
  s_waitcnt vmcnt(0)
  s_branch L_chkR_104
L_gotR_105:
  v_lshlrev_b32 v28, 16, v20
  v_and_b32 v29, 0xffff0000, v20
  v_lshlrev_b32 v30, 16, v21
  v_and_b32 v31, 0xffff0000, v21
  v_lshlrev_b32 v32, 16, v22
  v_and_b32 v33, 0xffff0000, v22
  v_lshlrev_b32 v34, 16, v23
  v_and_b32 v35, 0xffff0000, v23
  v_add_f32 v28, 1.0, v28
  v_add_f32 v29, 1.0, v29
  v_add_f32 v30, 1.0, v30
  v_add_f32 v31, 1.0, v31
  v_add_f32 v32, 1.0, v32
  v_add_f32 v33, 1.0, v33
  v_add_f32 v34, 1.0, v34
  v_add_f32 v35, 1.0, v35
  v_cvt_pk_bf16_f32 v20, v28, v29
  v_cvt_pk_bf16_f32 v21, v30, v31
  v_cvt_pk_bf16_f32 v22, v32, v33
  v_cvt_pk_bf16_f32 v23, v34, v35
L_spin_106:
  ds_read_b32 v7, v38 offset:8
  s_waitcnt lgkmcnt(0)
  v_readfirstlane_b32 s60, v7
  s_nop 0
  s_cmp_ge_u32 s60, 1
  s_cbranch_scc1 L_spun_107
  s_add_u32 s64, s64, 1
  s_cmp_gt_u32 s64, 200000
  s_cbranch_scc1 L_exit
  s_sleep 1
  s_branch L_spin_106
L_spun_107:
  s_mul_i32 s60, s67, 5120
  v_add_u32 v36, s60, v1
  ds_write_b128 v36, v[8:11] offset:5632
  ds_write_b128 v36, v[12:15] offset:6656
  ds_write_b128 v36, v[16:19] offset:7680
  ds_write_b128 v36, v[20:23] offset:8704
  ds_write_b128 v36, v[24:27] offset:9728
L_norows2_103:
  buffer_load_dwordx4 v[88:91], v4, s[48:51], s40 offen
  s_add_u32 s40, s40, 1024
  s_waitcnt vmcnt(3)
  buffer_load_dwordx4 v[92:95], v4, s[48:51], s40 offen
  s_add_u32 s40, s40, 1024
  s_waitcnt vmcnt(3)
  buffer_load_dwordx4 v[96:99], v4, s[48:51], s40 offen
  s_add_u32 s40, s40, 1024
  s_waitcnt vmcnt(3)
  buffer_load_dwordx4 v[100:103], v4, s[48:51], s40 offen
  s_add_u32 s40, s40, 25600
  s_waitcnt vmcnt(3)
  buffer_load_dwordx4 v[104:107], v4, s[48:51], s40 offen
  s_add_u32 s40, s40, 1024
  s_waitcnt vmcnt(3)
  buffer_load_dwordx4 v[108:111], v4, s[48:51], s40 offen
  s_add_u32 s40, s40, 1024
  s_waitcnt vmcnt(3)
  buffer_load_dwordx4 v[112:115], v4, s[48:51], s40 offen
  s_add_u32 s40, s40, 1024
  s_waitcnt vmcnt(3)
  buffer_load_dwordx4 v[116:119], v4, s[48:51], s40 offen
  s_add_u32 s40, s40, 1024
  v_perm_b32 v5, v76, v72, s62
  v_perm_b32 v76, v76, v72, s63
  v_mov_b32 v72, v5
  v_perm_b32 v5, v77, v73, s62
  v_perm_b32 v6, v77, v73, s63
  v_perm_b32 v73, v84, v80, s62
  v_perm_b32 v77, v84, v80, s63
  v_mov_b32 v80, v5
  v_mov_b32 v84, v6
  v_perm_b32 v5, v78, v74, s62
  v_perm_b32 v6, v78, v74, s63
  v_perm_b32 v74, v92, v88, s62
  v_perm_b32 v78, v92, v88, s63
  v_mov_b32 v88, v5
  v_mov_b32 v92, v6
  v_perm_b32 v5, v79, v75, s62
  v_perm_b32 v6, v79, v75, s63
  v_perm_b32 v75, v100, v96, s62
  v_perm_b32 v79, v100, v96, s63
  v_mov_b32 v96, v5
  v_mov_b32 v100, v6
  v_perm_b32 v5, v85, v81, s62
  v_perm_b32 v85, v85, v81, s63
  v_mov_b32 v81, v5
  v_perm_b32 v5, v86, v82, s62
  v_perm_b32 v6, v86, v82, s63
  v_perm_b32 v82, v93, v89, s62
  v_perm_b32 v86, v93, v89, s63
  v_mov_b32 v89, v5
  v_mov_b32 v93, v6
  v_perm_b32 v5, v87, v83, s62
  v_perm_b32 v6, v87, v83, s63
  v_perm_b32 v83, v101, v97, s62
  v_perm_b32 v87, v101, v97, s63
  v_mov_b32 v97, v5
  v_mov_b32 v101, v6
  v_perm_b32 v5, v94, v90, s62
  v_perm_b32 v94, v94, v90, s63
  v_mov_b32 v90, v5
  v_perm_b32 v5, v95, v91, s62
  v_perm_b32 v6, v95, v91, s63
  v_perm_b32 v91, v102, v98, s62
  v_perm_b32 v95, v102, v98, s63
  v_mov_b32 v98, v5
  v_mov_b32 v102, v6
  v_perm_b32 v5, v103, v99, s62
  v_perm_b32 v103, v103, v99, s63
  v_mov_b32 v99, v5
  s_waitcnt vmcnt(3)
  buffer_load_dwordx4 v[120:123], v4, s[48:51], s40 offen
  s_add_u32 s40, s40, 1024
  s_waitcnt vmcnt(3)
  buffer_load_dwordx4 v[124:127], v4, s[48:51], s40 offen
  s_add_u32 s40, s40, 1024
  s_waitcnt vmcnt(3)
  buffer_load_dwordx4 v[128:131], v4, s[48:51], s40 offen
  s_add_u32 s40, s40, 1024
  s_waitcnt vmcnt(3)
  buffer_load_dwordx4 v[132:135], v4, s[48:51], s40 offen
  s_add_u32 s40, s40, 25600
  s_waitcnt vmcnt(3)
  buffer_load_dwordx4 v[136:139], v4, s[48:51], s40 offen
  s_add_u32 s40, s40, 1024
  s_waitcnt vmcnt(3)
  buffer_load_dwordx4 v[140:143], v4, s[48:51], s40 offen
  s_add_u32 s40, s40, 1024
  s_waitcnt vmcnt(3)
  buffer_load_dwordx4 v[144:147], v4, s[48:51], s40 offen
  s_add_u32 s40, s40, 1024
  s_waitcnt vmcnt(3)
  buffer_load_dwordx4 v[148:151], v4, s[48:51], s40 offen
  s_add_u32 s40, s40, 1024
  v_perm_b32 v5, v108, v104, s62
  v_perm_b32 v108, v108, v104, s63
  v_mov_b32 v104, v5
  v_perm_b32 v5, v109, v105, s62
  v_perm_b32 v6, v109, v105, s63
  v_perm_b32 v105, v116, v112, s62
  v_perm_b32 v109, v116, v112, s63
  v_mov_b32 v112, v5
  v_mov_b32 v116, v6
  v_perm_b32 v5, v110, v106, s62
  v_perm_b32 v6, v110, v106, s63
  v_perm_b32 v106, v124, v120, s62
  v_perm_b32 v110, v124, v120, s63
  v_mov_b32 v120, v5
  v_mov_b32 v124, v6
  v_perm_b32 v5, v111, v107, s62
  v_perm_b32 v6, v111, v107, s63
  v_perm_b32 v107, v132, v128, s62
  v_perm_b32 v111, v132, v128, s63
  v_mov_b32 v128, v5
  v_mov_b32 v132, v6
  v_perm_b32 v5, v117, v113, s62
  v_perm_b32 v117, v117, v113, s63
  v_mov_b32 v113, v5
  v_perm_b32 v5, v118, v114, s62
  v_perm_b32 v6, v118, v114, s63
  v_perm_b32 v114, v125, v121, s62
  v_perm_b32 v118, v125, v121, s63
  v_mov_b32 v121, v5
  v_mov_b32 v125, v6
  v_perm_b32 v5, v119, v115, s62
  v_perm_b32 v6, v119, v115, s63
  v_perm_b32 v115, v133, v129, s62
  v_perm_b32 v119, v133, v129, s63
  v_mov_b32 v129, v5
  v_mov_b32 v133, v6
  v_perm_b32 v5, v126, v122, s62
  v_perm_b32 v126, v126, v122, s63
  v_mov_b32 v122, v5
  v_perm_b32 v5, v127, v123, s62
  v_perm_b32 v6, v127, v123, s63
  v_perm_b32 v123, v134, v130, s62
  v_perm_b32 v127, v134, v130, s63
  v_mov_b32 v130, v5
  v_mov_b32 v134, v6
  v_perm_b32 v5, v135, v131, s62
  v_perm_b32 v135, v135, v131, s63
  v_mov_b32 v131, v5
  s_waitcnt vmcnt(3)
  buffer_load_dwordx4 v[152:155], v4, s[48:51], s40 offen
  s_add_u32 s40, s40, 1024
  s_waitcnt vmcnt(3)
  buffer_load_dwordx4 v[156:159], v4, s[48:51], s40 offen
  s_add_u32 s40, s40, 1024
  s_waitcnt vmcnt(3)
  buffer_load_dwordx4 v[160:163], v4, s[48:51], s40 offen
  s_add_u32 s40, s40, 1024
  s_waitcnt vmcnt(3)
  buffer_load_dwordx4 v[164:167], v4, s[48:51], s40 offen
  s_waitcnt vmcnt(0)
  v_perm_b32 v5, v140, v136, s62
  v_perm_b32 v140, v140, v136, s63
  v_mov_b32 v136, v5
  v_perm_b32 v5, v141, v137, s62
  v_perm_b32 v6, v141, v137, s63
  v_perm_b32 v137, v148, v144, s62
  v_perm_b32 v141, v148, v144, s63
  v_mov_b32 v144, v5
  v_mov_b32 v148, v6
  v_perm_b32 v5, v142, v138, s62
  v_perm_b32 v6, v142, v138, s63
  v_perm_b32 v138, v156, v152, s62
  v_perm_b32 v142, v156, v152, s63
  v_mov_b32 v152, v5
  v_mov_b32 v156, v6
  v_perm_b32 v5, v143, v139, s62
  v_perm_b32 v6, v143, v139, s63
  v_perm_b32 v139, v164, v160, s62
  v_perm_b32 v143, v164, v160, s63
  v_mov_b32 v160, v5
  v_mov_b32 v164, v6
  v_perm_b32 v5, v149, v145, s62
  v_perm_b32 v149, v149, v145, s63
  v_mov_b32 v145, v5
  v_perm_b32 v5, v150, v146, s62
  v_perm_b32 v6, v150, v146, s63
  v_perm_b32 v146, v157, v153, s62
  v_perm_b32 v150, v157, v153, s63
  v_mov_b32 v153, v5
  v_mov_b32 v157, v6
  v_perm_b32 v5, v151, v147, s62
  v_perm_b32 v6, v151, v147, s63
  v_perm_b32 v147, v165, v161, s62
  v_perm_b32 v151, v165, v161, s63
  v_mov_b32 v161, v5
  v_mov_b32 v165, v6
  v_perm_b32 v5, v158, v154, s62
  v_perm_b32 v158, v158, v154, s63
  v_mov_b32 v154, v5
  v_perm_b32 v5, v159, v155, s62
  v_perm_b32 v6, v159, v155, s63
  v_perm_b32 v155, v166, v162, s62
  v_perm_b32 v159, v166, v162, s63
  v_mov_b32 v162, v5
  v_mov_b32 v166, v6
  v_perm_b32 v5, v167, v163, s62
  v_perm_b32 v167, v167, v163, s63
  v_mov_b32 v163, v5
  s_branch L_wo
L_prodh:
  s_mov_b32 s48, s12
  s_mov_b32 s49, s13
  s_mov_b32 s50, 4194304
  s_mov_b32 s51, 0x20000
  s_lshl_b32 s40, s37, 17
  s_lshl_b32 s60, s67, 8
  s_add_u32 s40, s40, s60
  v_lshlrev_b32 v4, 4, v3
  v_lshl_add_u32 v4, v2, 13, v4
  buffer_load_dwordx4 v[40:43], v4, s[48:51], s40 offen
  s_add_u32 s40, s40, 1024
  buffer_load_dwordx4 v[44:47], v4, s[48:51], s40 offen
  s_add_u32 s40, s40, 1024
  s_waitcnt vmcnt(1)
  buffer_load_dwordx4 v[48:51], v4, s[48:51], s40 offen
  s_add_u32 s40, s40, 1024
  s_waitcnt vmcnt(1)
  buffer_load_dwordx4 v[52:55], v4, s[48:51], s40 offen
  s_add_u32 s40, s40, 1024
  s_waitcnt vmcnt(1)
  buffer_load_dwordx4 v[56:59], v4, s[48:51], s40 offen
  s_add_u32 s40, s40, 1024
  s_waitcnt vmcnt(1)
  buffer_load_dwordx4 v[60:63], v4, s[48:51], s40 offen
  s_add_u32 s40, s40, 1024
  s_waitcnt vmcnt(1)
  buffer_load_dwordx4 v[64:67], v4, s[48:51], s40 offen
  s_add_u32 s40, s40, 1024
  s_waitcnt vmcnt(1)
  buffer_load_dwordx4 v[68:71], v4, s[48:51], s40 offen
  s_add_u32 s40, s40, 25600
  s_waitcnt vmcnt(1)
  buffer_load_dwordx4 v[72:75], v4, s[48:51], s40 offen
  s_add_u32 s40, s40, 1024
  s_waitcnt vmcnt(1)
  buffer_load_dwordx4 v[76:79], v4, s[48:51], s40 offen
  s_add_u32 s40, s40, 1024
  v_perm_b32 v5, v44, v40, s62
  v_perm_b32 v44, v44, v40, s63
  v_mov_b32 v40, v5
  v_perm_b32 v5, v45, v41, s62
  v_perm_b32 v6, v45, v41, s63
  v_perm_b32 v41, v52, v48, s62
  v_perm_b32 v45, v52, v48, s63
  v_mov_b32 v48, v5
  v_mov_b32 v52, v6
  v_perm_b32 v5, v46, v42, s62
  v_perm_b32 v6, v46, v42, s63
  v_perm_b32 v42, v60, v56, s62
  v_perm_b32 v46, v60, v56, s63
  v_mov_b32 v56, v5
  v_mov_b32 v60, v6
  v_perm_b32 v5, v47, v43, s62
  v_perm_b32 v6, v47, v43, s63
  v_perm_b32 v43, v68, v64, s62
  v_perm_b32 v47, v68, v64, s63
  v_mov_b32 v64, v5
  v_mov_b32 v68, v6
  v_perm_b32 v5, v53, v49, s62
  v_perm_b32 v53, v53, v49, s63
  v_mov_b32 v49, v5
  v_perm_b32 v5, v54, v50, s62
  v_perm_b32 v6, v54, v50, s63
  v_perm_b32 v50, v61, v57, s62
  v_perm_b32 v54, v61, v57, s63
  v_mov_b32 v57, v5
  v_mov_b32 v61, v6
  v_perm_b32 v5, v55, v51, s62
  v_perm_b32 v6, v55, v51, s63
  v_perm_b32 v51, v69, v65, s62
  v_perm_b32 v55, v69, v65, s63
  v_mov_b32 v65, v5
  v_mov_b32 v69, v6
  v_perm_b32 v5, v62, v58, s62
  v_perm_b32 v62, v62, v58, s63
  v_mov_b32 v58, v5
  v_perm_b32 v5, v63, v59, s62
  v_perm_b32 v6, v63, v59, s63
  v_perm_b32 v59, v70, v66, s62
  v_perm_b32 v63, v70, v66, s63
  v_mov_b32 v66, v5
  v_mov_b32 v70, v6
  v_perm_b32 v5, v71, v67, s62
  v_perm_b32 v71, v71, v67, s63
  v_mov_b32 v67, v5
  s_waitcnt vmcnt(1)
  buffer_load_dwordx4 v[80:83], v4, s[48:51], s40 offen
  s_add_u32 s40, s40, 1024
  s_waitcnt vmcnt(1)
  buffer_load_dwordx4 v[84:87], v4, s[48:51], s40 offen
  s_add_u32 s40, s40, 1024
  s_waitcnt vmcnt(1)
  buffer_load_dwordx4 v[88:91], v4, s[48:51], s40 offen
  s_add_u32 s40, s40, 1024
  s_waitcnt vmcnt(1)
  buffer_load_dwordx4 v[92:95], v4, s[48:51], s40 offen
  s_add_u32 s40, s40, 1024
  s_waitcnt vmcnt(1)
  buffer_load_dwordx4 v[96:99], v4, s[48:51], s40 offen
  s_add_u32 s40, s40, 1024
  s_waitcnt vmcnt(1)
  buffer_load_dwordx4 v[100:103], v4, s[48:51], s40 offen
  s_add_u32 s40, s40, 25600
  s_waitcnt vmcnt(1)
  buffer_load_dwordx4 v[104:107], v4, s[48:51], s40 offen
  s_add_u32 s40, s40, 1024
  s_waitcnt vmcnt(1)
  buffer_load_dwordx4 v[108:111], v4, s[48:51], s40 offen
  s_add_u32 s40, s40, 1024
  v_perm_b32 v5, v76, v72, s62
  v_perm_b32 v76, v76, v72, s63
  v_mov_b32 v72, v5
  v_perm_b32 v5, v77, v73, s62
  v_perm_b32 v6, v77, v73, s63
  v_perm_b32 v73, v84, v80, s62
  v_perm_b32 v77, v84, v80, s63
  v_mov_b32 v80, v5
  v_mov_b32 v84, v6
  v_perm_b32 v5, v78, v74, s62
  v_perm_b32 v6, v78, v74, s63
  v_perm_b32 v74, v92, v88, s62
  v_perm_b32 v78, v92, v88, s63
  v_mov_b32 v88, v5
  v_mov_b32 v92, v6
  v_perm_b32 v5, v79, v75, s62
  v_perm_b32 v6, v79, v75, s63
  v_perm_b32 v75, v100, v96, s62
  v_perm_b32 v79, v100, v96, s63
  v_mov_b32 v96, v5
  v_mov_b32 v100, v6
  v_perm_b32 v5, v85, v81, s62
  v_perm_b32 v85, v85, v81, s63
  v_mov_b32 v81, v5
  v_perm_b32 v5, v86, v82, s62
  v_perm_b32 v6, v86, v82, s63
  v_perm_b32 v82, v93, v89, s62
  v_perm_b32 v86, v93, v89, s63
  v_mov_b32 v89, v5
  v_mov_b32 v93, v6
  v_perm_b32 v5, v87, v83, s62
  v_perm_b32 v6, v87, v83, s63
  v_perm_b32 v83, v101, v97, s62
  v_perm_b32 v87, v101, v97, s63
  v_mov_b32 v97, v5
  v_mov_b32 v101, v6
  v_perm_b32 v5, v94, v90, s62
  v_perm_b32 v94, v94, v90, s63
  v_mov_b32 v90, v5
  v_perm_b32 v5, v95, v91, s62
  v_perm_b32 v6, v95, v91, s63
  v_perm_b32 v91, v102, v98, s62
  v_perm_b32 v95, v102, v98, s63
  v_mov_b32 v98, v5
  v_mov_b32 v102, v6
  v_perm_b32 v5, v103, v99, s62
  v_perm_b32 v103, v103, v99, s63
  v_mov_b32 v99, v5
  s_waitcnt vmcnt(1)
  buffer_load_dwordx4 v[112:115], v4, s[48:51], s40 offen
  s_add_u32 s40, s40, 1024
  s_waitcnt vmcnt(1)
  buffer_load_dwordx4 v[116:119], v4, s[48:51], s40 offen
  s_add_u32 s40, s40, 1024
  s_waitcnt vmcnt(1)
  buffer_load_dwordx4 v[120:123], v4, s[48:51], s40 offen
  s_add_u32 s40, s40, 1024
  s_waitcnt vmcnt(1)
  buffer_load_dwordx4 v[124:127], v4, s[48:51], s40 offen
  s_add_u32 s40, s40, 1024
  s_waitcnt vmcnt(1)
  buffer_load_dwordx4 v[128:131], v4, s[48:51], s40 offen
  s_add_u32 s40, s40, 1024
  s_waitcnt vmcnt(1)
  s_cmp_lg_u32 s67, 0
  s_cbranch_scc1 L_noq_108
  s_load_dword s44, s[28:29], 0x80
  s_waitcnt lgkmcnt(0)
L_pollPN_109:
  s_cmp_lg_u32 s44, 0
  s_cbranch_scc1 L_gotPN_110
  s_add_u32 s64, s64, 1
  s_cmp_gt_u32 s64, 200000
  s_cbranch_scc1 L_exit
  s_load_dword s44, s[28:29], 0x80 glc
  s_waitcnt lgkmcnt(0)
  s_branch L_pollPN_109
L_gotPN_110:
  v_mov_b32 v26, s44
  ds_write_b32 v38, v26 offset:52
  s_lshl_b32 s60, s2, 9
  s_add_u32 s60, s60, 1835008
  v_lshl_add_u32 v7, v0, 3, s60
  s_add_u32 s61, s60, 4
L_pollPQ_111:
  s_load_dword s60, s[30:31], s61 glc
  s_waitcnt lgkmcnt(0)
  s_cmp_eq_u32 s60, s44
  s_cbranch_scc0 L_pollPQ_111_r
  global_load_dwordx2 v[8:9], v7, s[30:31] sc1
  s_waitcnt vmcnt(0)
  v_cmp_ne_u32 vcc, s44, v9
  s_cbranch_vccz L_gotPQ_112
L_pollPQ_111_r:
  s_add_u32 s64, s64, 1
  s_cmp_gt_u32 s64, 200000
  s_cbranch_scc1 L_exit
  s_sleep 8
  s_branch L_pollPQ_111
L_gotPQ_112:
  v_lshlrev_b32 v7, 2, v0
  ds_write_b32 v7, v8 offset:256
  s_mov_b64 exec, 1
  ds_add_u32 v38, v39 offset:8
  s_mov_b64 exec, -1
  s_mov_b64 exec, 1
  global_load_dword v7, v38, s[28:29] offset:136
L_pollN_113:
  s_waitcnt vmcnt(0)
  v_readfirstlane_b32 s45, v7
  s_nop 0
  s_cmp_eq_u32 s45, s44
  s_cbranch_scc1 L_gotN_114
  s_add_u32 s64, s64, 1
  s_cmp_gt_u32 s64, 200000
  s_cbranch_scc1 L_exit
  s_sleep 8
  global_load_dword v7, v38, s[28:29] offset:136 sc1
  s_branch L_pollN_113
L_gotN_114:
  s_mov_b64 exec, -1
  s_mov_b64 exec, 1
  ds_add_u32 v38, v39 offset:28
  s_mov_b64 exec, -1
L_noq_108:
  buffer_load_dwordx4 v[132:135], v4, s[48:51], s40 offen
  s_add_u32 s40, s40, 25600
  s_waitcnt vmcnt(1)
  buffer_load_dwordx4 v[136:139], v4, s[48:51], s40 offen
  s_add_u32 s40, s40, 1024
  s_waitcnt vmcnt(1)
  buffer_load_dwordx4 v[140:143], v4, s[48:51], s40 offen
  s_add_u32 s40, s40, 1024
  v_perm_b32 v5, v108, v104, s62
  v_perm_b32 v108, v108, v104, s63
  v_mov_b32 v104, v5
  v_perm_b32 v5, v109, v105, s62
  v_perm_b32 v6, v109, v105, s63
  v_perm_b32 v105, v116, v112, s62
  v_perm_b32 v109, v116, v112, s63
  v_mov_b32 v112, v5
  v_mov_b32 v116, v6
  v_perm_b32 v5, v110, v106, s62
  v_perm_b32 v6, v110, v106, s63
  v_perm_b32 v106, v124, v120, s62
  v_perm_b32 v110, v124, v120, s63
  v_mov_b32 v120, v5
  v_mov_b32 v124, v6
  v_perm_b32 v5, v111, v107, s62
  v_perm_b32 v6, v111, v107, s63
  v_perm_b32 v107, v132, v128, s62
  v_perm_b32 v111, v132, v128, s63
  v_mov_b32 v128, v5
  v_mov_b32 v132, v6
  v_perm_b32 v5, v117, v113, s62
  v_perm_b32 v117, v117, v113, s63
  v_mov_b32 v113, v5
  v_perm_b32 v5, v118, v114, s62
  v_perm_b32 v6, v118, v114, s63
  v_perm_b32 v114, v125, v121, s62
  v_perm_b32 v118, v125, v121, s63
  v_mov_b32 v121, v5
  v_mov_b32 v125, v6
  v_perm_b32 v5, v119, v115, s62
  v_perm_b32 v6, v119, v115, s63
  v_perm_b32 v115, v133, v129, s62
  v_perm_b32 v119, v133, v129, s63
  v_mov_b32 v129, v5
  v_mov_b32 v133, v6
  v_perm_b32 v5, v126, v122, s62
  v_perm_b32 v126, v126, v122, s63
  v_mov_b32 v122, v5
  v_perm_b32 v5, v127, v123, s62
  v_perm_b32 v6, v127, v123, s63
  v_perm_b32 v123, v134, v130, s62
  v_perm_b32 v127, v134, v130, s63
  v_mov_b32 v130, v5
  v_mov_b32 v134, v6
  v_perm_b32 v5, v135, v131, s62
  v_perm_b32 v135, v135, v131, s63
  v_mov_b32 v131, v5
  s_waitcnt vmcnt(1)
  buffer_load_dwordx4 v[144:147], v4, s[48:51], s40 offen
  s_add_u32 s40, s40, 1024
  s_waitcnt vmcnt(1)
  buffer_load_dwordx4 v[148:151], v4, s[48:51], s40 offen
  s_add_u32 s40, s40, 1024
  s_waitcnt vmcnt(1)
  buffer_load_dwordx4 v[152:155], v4, s[48:51], s40 offen
  s_add_u32 s40, s40, 1024
  s_waitcnt vmcnt(1)
  buffer_load_dwordx4 v[156:159], v4, s[48:51], s40 offen
  s_add_u32 s40, s40, 1024
  s_waitcnt vmcnt(1)
  buffer_load_dwordx4 v[160:163], v4, s[48:51], s40 offen
  s_add_u32 s40, s40, 1024
  s_waitcnt vmcnt(1)
  buffer_load_dwordx4 v[164:167], v4, s[48:51], s40 offen
  s_waitcnt vmcnt(0)
  v_perm_b32 v5, v140, v136, s62
  v_perm_b32 v140, v140, v136, s63
  v_mov_b32 v136, v5
  v_perm_b32 v5, v141, v137, s62
  v_perm_b32 v6, v141, v137, s63
  v_perm_b32 v137, v148, v144, s62
  v_perm_b32 v141, v148, v144, s63
  v_mov_b32 v144, v5
  v_mov_b32 v148, v6
  v_perm_b32 v5, v142, v138, s62
  v_perm_b32 v6, v142, v138, s63
  v_perm_b32 v138, v156, v152, s62
  v_perm_b32 v142, v156, v152, s63
  v_mov_b32 v152, v5
  v_mov_b32 v156, v6
  v_perm_b32 v5, v143, v139, s62
  v_perm_b32 v6, v143, v139, s63
  v_perm_b32 v139, v164, v160, s62
  v_perm_b32 v143, v164, v160, s63
  v_mov_b32 v160, v5
  v_mov_b32 v164, v6
  v_perm_b32 v5, v149, v145, s62
  v_perm_b32 v149, v149, v145, s63
  v_mov_b32 v145, v5
  v_perm_b32 v5, v150, v146, s62
  v_perm_b32 v6, v150, v146, s63
  v_perm_b32 v146, v157, v153, s62
  v_perm_b32 v150, v157, v153, s63
  v_mov_b32 v153, v5
  v_mov_b32 v157, v6
  v_perm_b32 v5, v151, v147, s62
  v_perm_b32 v6, v151, v147, s63
  v_perm_b32 v147, v165, v161, s62
  v_perm_b32 v151, v165, v161, s63
  v_mov_b32 v161, v5
  v_mov_b32 v165, v6
  v_perm_b32 v5, v158, v154, s62
  v_perm_b32 v158, v158, v154, s63
  v_mov_b32 v154, v5
  v_perm_b32 v5, v159, v155, s62
  v_perm_b32 v6, v159, v155, s63
  v_perm_b32 v155, v166, v162, s62
  v_perm_b32 v159, v166, v162, s63
  v_mov_b32 v162, v5
  v_mov_b32 v166, v6
  v_perm_b32 v5, v167, v163, s62
  v_perm_b32 v167, v167, v163, s63
  v_mov_b32 v163, v5
L_spin_115:
  ds_read_b32 v7, v38 offset:8
  s_waitcnt lgkmcnt(0)
  v_readfirstlane_b32 s60, v7
  s_nop 0
  s_cmp_ge_u32 s60, 1
  s_cbranch_scc1 L_spun_116
  s_add_u32 s64, s64, 1
  s_cmp_gt_u32 s64, 200000
  s_cbranch_scc1 L_exit
  s_sleep 4
  s_branch L_spin_115
L_spun_116:
  ds_read_b32 v7, v38 offset:52
  s_waitcnt lgkmcnt(0)
  v_readfirstlane_b32 s44, v7
L_wo:
L_wodone:
  s_setprio 2
L_spin_117:
  ds_read_b32 v7, v38 offset:28
  s_waitcnt lgkmcnt(0)
  v_readfirstlane_b32 s60, v7
  s_nop 0
  s_cmp_ge_u32 s60, 1
  s_cbranch_scc1 L_spun_118
  s_add_u32 s64, s64, 1
  s_cmp_gt_u32 s64, 200000
  s_cbranch_scc1 L_exit
  s_sleep 4
  s_branch L_spin_117
L_spun_118:
  v_lshlrev_b32 v28, 3, v0
  s_lshl_b32 s60, s67, 8
  v_lshl_add_u32 v29, v0, 2, s60
  v_lshl_add_u32 v30, v2, 4, s60
  v_lshrrev_b32 v31, 2, v0
  v_and_b32 v32, 3, v0
  v_lshl_add_u32 v31, v32, 4, v31
  v_lshlrev_b32 v36, 2, v31
  s_lshl_b32 s61, s35, 12
  s_add_u32 s61, s61, 65536
  v_add_u32 v32, s61, v29
  v_mov_b32 v33, 1.0
  v_mov_b32 v34, 1.0
  v_mov_b32 v35, 1.0
  s_nop 1
  v_mov_b32_dpp v35, v38 quad_perm:[0,1,2,3] row_mask:0x4 bank_mask:0xf
L_spin_119:
  ds_read_b32 v7, v38 offset:16
  s_waitcnt lgkmcnt(0)
  v_readfirstlane_b32 s60, v7
  s_nop 0
  s_cmp_ge_u32 s60, 8
  s_cbranch_scc1 L_spun_120
  s_add_u32 s64, s64, 1
  s_cmp_gt_u32 s64, 200000
  s_cbranch_scc1 L_exit
  s_sleep 1
  s_branch L_spin_119
L_spun_120:
L_dry_o:
  ds_read_b64 v[8:9], v28 offset:512
  ds_read_b64 v[10:11], v28 offset:1024
  ds_read_b64 v[12:13], v28 offset:1536
  ds_read_b64 v[14:15], v28 offset:2048
  ds_read_b64 v[16:17], v28 offset:2560
  ds_read_b64 v[18:19], v28 offset:3072
  ds_read_b64 v[20:21], v28 offset:3584
  ds_read_b64 v[22:23], v28 offset:4096
  s_waitcnt lgkmcnt(4)
  v_add_f32 v8, v8, v10
  v_add_f32 v9, v9, v11
  v_add_f32 v12, v12, v14
  v_add_f32 v13, v13, v15
  v_add_f32 v8, v8, v12
  v_add_f32 v9, v9, v13
  s_waitcnt lgkmcnt(0)
  v_add_f32 v16, v16, v18
  v_add_f32 v17, v17, v19
  v_add_f32 v20, v20, v22
  v_add_f32 v21, v21, v23
  v_add_f32 v16, v16, v20
  v_add_f32 v17, v17, v21
  v_add_f32 v8, v8, v16
  v_add_f32 v9, v9, v17
  v_cvt_pk_bf16_f32 v7, v8, v9
  ds_write_b32 v29, v7 offset:4608
  ds_read_b128 v[8:11], v30 offset:4608
  ds_read_b128 v[12:15], v30 offset:4672
  ds_read_b128 v[16:19], v30 offset:4736
  ds_read_b128 v[20:23], v30 offset:4800
  s_waitcnt lgkmcnt(0)
  v_mfma_f32_16x16x32_bf16 v[24:27], v[8:11], v[40:43], 0
  v_mfma_f32_16x16x32_bf16 v[24:27], v[12:15], v[72:75], v[24:27]
  v_mfma_f32_16x16x32_bf16 v[24:27], v[16:19], v[104:107], v[24:27]
  v_mfma_f32_16x16x32_bf16 v[24:27], v[20:23], v[136:139], v[24:27]
  v_mfma_f32_16x16x32_bf16 v[40:43], v[8:11], v[44:47], 0
  v_mfma_f32_16x16x32_bf16 v[40:43], v[12:15], v[76:79], v[40:43]
  v_mfma_f32_16x16x32_bf16 v[40:43], v[16:19], v[108:111], v[40:43]
  v_mfma_f32_16x16x32_bf16 v[40:43], v[20:23], v[140:143], v[40:43]
  v_mfma_f32_16x16x32_bf16 v[44:47], v[8:11], v[48:51], 0
  v_mfma_f32_16x16x32_bf16 v[44:47], v[12:15], v[80:83], v[44:47]
  v_mfma_f32_16x16x32_bf16 v[44:47], v[16:19], v[112:115], v[44:47]
  v_mfma_f32_16x16x32_bf16 v[44:47], v[20:23], v[144:147], v[44:47]
  v_mfma_f32_16x16x32_bf16 v[48:51], v[8:11], v[52:55], 0
  v_mfma_f32_16x16x32_bf16 v[48:51], v[12:15], v[84:87], v[48:51]
  v_mfma_f32_16x16x32_bf16 v[48:51], v[16:19], v[116:119], v[48:51]
  v_mfma_f32_16x16x32_bf16 v[48:51], v[20:23], v[148:151], v[48:51]
  v_mfma_f32_16x16x32_bf16 v[52:55], v[8:11], v[56:59], 0
  v_mfma_f32_16x16x32_bf16 v[52:55], v[12:15], v[88:91], v[52:55]
  v_mfma_f32_16x16x32_bf16 v[52:55], v[16:19], v[120:123], v[52:55]
  v_mfma_f32_16x16x32_bf16 v[52:55], v[20:23], v[152:155], v[52:55]
  v_mfma_f32_16x16x32_bf16 v[56:59], v[8:11], v[60:63], 0
  v_mfma_f32_16x16x32_bf16 v[56:59], v[12:15], v[92:95], v[56:59]
  v_mfma_f32_16x16x32_bf16 v[56:59], v[16:19], v[124:127], v[56:59]
  v_mfma_f32_16x16x32_bf16 v[56:59], v[20:23], v[156:159], v[56:59]
  v_mfma_f32_16x16x32_bf16 v[60:63], v[8:11], v[64:67], 0
  v_mfma_f32_16x16x32_bf16 v[60:63], v[12:15], v[96:99], v[60:63]
  v_mfma_f32_16x16x32_bf16 v[60:63], v[16:19], v[128:131], v[60:63]
  v_mfma_f32_16x16x32_bf16 v[60:63], v[20:23], v[160:163], v[60:63]
  v_mfma_f32_16x16x32_bf16 v[64:67], v[8:11], v[68:71], 0
  v_mfma_f32_16x16x32_bf16 v[64:67], v[12:15], v[100:103], v[64:67]
  v_mfma_f32_16x16x32_bf16 v[64:67], v[16:19], v[132:135], v[64:67]
  v_mfma_f32_16x16x32_bf16 v[64:67], v[20:23], v[164:167], v[64:67]
L_dry_o2:
  v_mov_b32_dpp v33, v24 quad_perm:[0,1,2,3] row_mask:0x1 bank_mask:0xf
  v_mov_b32_dpp v34, v48 quad_perm:[0,1,2,3] row_mask:0x1 bank_mask:0xf
  s_nop 1
  v_mov_b32_dpp v35, v60 quad_perm:[0,1,2,3] row_mask:0x1 bank_mask:0xf
  v_mov_b32_dpp v33, v40 quad_perm:[0,1,2,3] row_mask:0x2 bank_mask:0xf
  v_mov_b32_dpp v34, v52 quad_perm:[0,1,2,3] row_mask:0x2 bank_mask:0xf
  s_nop 0
  v_mov_b32_dpp v35, v64 quad_perm:[0,1,2,3] row_mask:0x2 bank_mask:0xf
  v_mov_b32_dpp v33, v44 quad_perm:[0,1,2,3] row_mask:0x4 bank_mask:0xf
  v_mov_b32_dpp v34, v56 quad_perm:[0,1,2,3] row_mask:0x4 bank_mask:0xf
  ds_bpermute_b32 v33, v36, v33
  ds_bpermute_b32 v34, v36, v34
  ds_bpermute_b32 v35, v36, v35
  s_waitcnt lgkmcnt(2)
  global_atomic_add_f32 v32, v33, s[30:31] offset:0
  s_waitcnt lgkmcnt(1)
  global_atomic_add_f32 v32, v34, s[30:31] offset:1024
  s_waitcnt lgkmcnt(0)
  global_atomic_add_f32 v32, v35, s[30:31] offset:2048
  s_cmp_lt_u32 s67, 2
  s_cbranch_scc1 L_g01_121
  s_mov_b64 exec, 1
  ds_add_u32 v38, v39 offset:44
  s_mov_b64 exec, -1
L_g01_121:
  s_cmp_lg_u32 s67, 2
  s_cbranch_scc1 L_nodry_122
  s_cmp_lg_u32 s39, 0
  s_cbranch_scc1 L_dryf_123
  s_cmp_ge_u32 s57, 100
  s_cbranch_scc1 L_exit
  s_mov_b64 exec, 0
  s_branch L_dry_r
L_dryf_123:
  s_mov_b64 exec, 0
  s_branch L_dry_l
L_nodry_122:
  s_cmp_ge_u32 s67, 2
  s_cbranch_scc1 L_exit
  s_cmp_lt_u32 s57, 100
  s_cbranch_scc1 L_recv
  s_cmp_eq_u32 s39, 0
  s_cbranch_scc1 L_exit
  s_lshl_b32 s45, s36, 1
  s_add_u32 s45, s45, s67
  s_lshl_b32 s45, s45, 6
  s_add_u32 s45, s45, s38
  s_lshl_b32 s45, s45, 7
  s_add_u32 s45, s45, 131072
  s_lshl_b32 s60, s67, 2
  v_mov_b32 v7, s60
  ds_read_b32 v7, v7 offset:56
  s_mul_i32 s60, s67, 5120
  v_add_u32 v4, s60, v1
  ds_read_b128 v[72:75], v4 offset:5632
  ds_read_b128 v[76:79], v4 offset:6656
  ds_read_b128 v[80:83], v4 offset:7680
  ds_read_b128 v[84:87], v4 offset:8704
  s_lshl_b32 s41, s36, 1
  s_add_u32 s41, s41, s67
  s_lshl_b32 s41, s41, 12
  s_add_u32 s41, s41, 65536
  v_add_u32 v5, s41, v1
  v_mov_b32 v6, s41
  s_lshl_b32 s60, s67, 10
  v_add_u32 v4, s60, v1
  s_waitcnt lgkmcnt(0)
  v_readfirstlane_b32 s61, v7
  s_nop 0
  s_cmp_eq_u32 s61, s44
  s_cbranch_scc1 L_notlate_124
  s_mov_b64 exec, 1
  ds_add_u32 v38, v39 offset:44
  s_mov_b64 exec, -1
L_notlate_124:
  v_lshlrev_b32 v88, 16, v72
  v_and_b32 v89, 0xffff0000, v72
  v_lshlrev_b32 v90, 16, v73
  v_and_b32 v91, 0xffff0000, v73
  v_lshlrev_b32 v92, 16, v74
  v_and_b32 v93, 0xffff0000, v74
  v_lshlrev_b32 v94, 16, v75
  v_and_b32 v95, 0xffff0000, v75
  v_lshlrev_b32 v96, 16, v76
  v_and_b32 v97, 0xffff0000, v76
  v_lshlrev_b32 v98, 16, v77
  v_and_b32 v99, 0xffff0000, v77
  v_lshlrev_b32 v100, 16, v78
  v_and_b32 v101, 0xffff0000, v78
  v_lshlrev_b32 v102, 16, v79
  v_and_b32 v103, 0xffff0000, v79
  v_lshlrev_b32 v104, 16, v80
  v_and_b32 v105, 0xffff0000, v80
  v_lshlrev_b32 v106, 16, v81
  v_and_b32 v107, 0xffff0000, v81
  v_lshlrev_b32 v108, 16, v82
  v_and_b32 v109, 0xffff0000, v82
  v_lshlrev_b32 v110, 16, v83
  v_and_b32 v111, 0xffff0000, v83
  v_lshlrev_b32 v112, 16, v84
  v_and_b32 v113, 0xffff0000, v84
  v_lshlrev_b32 v114, 16, v85
  v_and_b32 v115, 0xffff0000, v85
  v_lshlrev_b32 v116, 16, v86
  v_and_b32 v117, 0xffff0000, v86
  v_lshlrev_b32 v118, 16, v87
  v_and_b32 v119, 0xffff0000, v87
  s_cmp_lg_u32 s61, s44
  s_cbranch_scc1 L_notlate2_126
  s_sleep 10
  global_load_dwordx4 v[120:123], v5, s[30:31] offset:0 sc1
  global_load_dwordx4 v[124:127], v5, s[30:31] offset:1024 sc1
  global_load_dwordx4 v[128:131], v5, s[30:31] offset:2048 sc1
  s_mov_b64 exec, 1
  ds_add_u32 v38, v39 offset:44
  s_mov_b64 exec, -1
  s_branch L_lj_125
L_notlate2_126:
L_pollH_127:
  s_load_dword s60, s[30:31], s45 glc
  s_waitcnt lgkmcnt(0)
  s_cmp_eq_u32 s60, s44
  s_cbranch_scc1 L_gotH_128
  s_add_u32 s64, s64, 1
  s_cmp_gt_u32 s64, 200000
  s_cbranch_scc1 L_exit
  s_sleep 2
  s_branch L_pollH_127
L_gotH_128:
  s_sleep 18
  global_load_dwordx4 v[120:123], v5, s[30:31] offset:0 sc1
  global_load_dwordx4 v[124:127], v5, s[30:31] offset:1024 sc1
  global_load_dwordx4 v[128:131], v5, s[30:31] offset:2048 sc1
L_lj_125:
  s_mov_b64 exec, 1
  ds_add_u32 v38, v39 offset:48
  s_mov_b64 exec, -1
L_pollF_129:
  s_waitcnt vmcnt(0)
  v_min3_f32 v7, v123, v127, v131
  v_cmp_neq_f32 vcc, 0x42000000, v7
  s_cbranch_vccz L_gotF_130
  s_add_u32 s64, s64, 1
  s_cmp_gt_u32 s64, 200000
  s_cbranch_scc1 L_exit
  global_load_dwordx4 v[120:123], v5, s[30:31] offset:0 sc1
  global_load_dwordx4 v[124:127], v5, s[30:31] offset:1024 sc1
  global_load_dwordx4 v[128:131], v5, s[30:31] offset:2048 sc1
  s_branch L_pollF_129
L_gotF_130:
L_dry_l:
  v_cvt_pk_bf16_f32 v16, v120, v121
  v_cvt_pk_bf16_f32 v17, v122, v124
  v_cvt_pk_bf16_f32 v18, v125, v126
  v_cvt_pk_bf16_f32 v19, v128, v129
  v_lshlrev_b32 v8, 16, v16
  v_and_b32 v9, 0xffff0000, v16
  v_lshlrev_b32 v10, 16, v17
  v_and_b32 v11, 0xffff0000, v17
  v_lshlrev_b32 v12, 16, v18
  v_and_b32 v13, 0xffff0000, v18
  v_lshlrev_b32 v14, 16, v19
  v_and_b32 v15, 0xffff0000, v19
  v_pk_mul_f32 v[8:9], v[96:97], v[8:9]
  v_pk_mul_f32 v[10:11], v[98:99], v[10:11]
  v_pk_mul_f32 v[12:13], v[100:101], v[12:13]
  v_pk_mul_f32 v[14:15], v[102:103], v[14:15]
  v_cvt_pk_bf16_f32 v16, v8, v9
  v_cvt_pk_bf16_f32 v17, v10, v11
  v_cvt_pk_bf16_f32 v18, v12, v13
  v_cvt_pk_bf16_f32 v19, v14, v15
  v_lshlrev_b32 v8, 16, v16
  v_and_b32 v9, 0xffff0000, v16
  v_lshlrev_b32 v10, 16, v17
  v_and_b32 v11, 0xffff0000, v17
  v_lshlrev_b32 v12, 16, v18
  v_and_b32 v13, 0xffff0000, v18
  v_lshlrev_b32 v14, 16, v19
  v_and_b32 v15, 0xffff0000, v19
  v_pk_add_f32 v[8:9], v[88:89], v[8:9]
  v_pk_add_f32 v[10:11], v[90:91], v[10:11]
  v_pk_add_f32 v[12:13], v[92:93], v[12:13]
  v_pk_add_f32 v[14:15], v[94:95], v[14:15]
  v_cvt_pk_bf16_f32 v28, v8, v9
  v_cvt_pk_bf16_f32 v29, v10, v11
  v_cvt_pk_bf16_f32 v30, v12, v13
  v_cvt_pk_bf16_f32 v31, v14, v15
  v_lshlrev_b32 v8, 16, v28
  v_and_b32 v9, 0xffff0000, v28
  v_lshlrev_b32 v10, 16, v29
  v_and_b32 v11, 0xffff0000, v29
  v_lshlrev_b32 v12, 16, v30
  v_and_b32 v13, 0xffff0000, v30
  v_lshlrev_b32 v14, 16, v31
  v_and_b32 v15, 0xffff0000, v31
  v_readfirstlane_b32 s60, v8
  s_nop 1
  v_pk_add_f32 v[16:17], v[8:9], s[60:61] op_sel_hi:[1,0] neg_lo:[0,1] neg_hi:[0,1]
  v_pk_add_f32 v[18:19], v[10:11], s[60:61] op_sel_hi:[1,0] neg_lo:[0,1] neg_hi:[0,1]
  v_pk_add_f32 v[20:21], v[12:13], s[60:61] op_sel_hi:[1,0] neg_lo:[0,1] neg_hi:[0,1]
  v_pk_add_f32 v[22:23], v[14:15], s[60:61] op_sel_hi:[1,0] neg_lo:[0,1] neg_hi:[0,1]
  v_pk_add_f32 v[24:25], v[16:17], v[18:19]
  v_pk_mul_f32 v[26:27], v[16:17], v[16:17]
  v_pk_add_f32 v[24:25], v[24:25], v[20:21]
  v_pk_fma_f32 v[26:27], v[18:19], v[18:19], v[26:27]
  v_pk_add_f32 v[24:25], v[24:25], v[22:23]
  v_pk_fma_f32 v[26:27], v[20:21], v[20:21], v[26:27]
  v_add_f32 v24, v24, v25
  v_pk_fma_f32 v[26:27], v[22:23], v[22:23], v[26:27]
  v_add_f32 v25, v26, v27
  v_add_f32_dpp v24, v24, v24 quad_perm:[1,0,3,2] row_mask:0xf bank_mask:0xf
  s_nop 0
  v_add_f32_dpp v25, v25, v25 quad_perm:[1,0,3,2] row_mask:0xf bank_mask:0xf
  v_add_f32_dpp v24, v24, v24 quad_perm:[2,3,0,1] row_mask:0xf bank_mask:0xf
  s_nop 0
  v_add_f32_dpp v25, v25, v25 quad_perm:[2,3,0,1] row_mask:0xf bank_mask:0xf
  v_add_f32_dpp v24, v24, v24 row_ror:4 row_mask:0xf bank_mask:0xf
  s_nop 0
  v_add_f32_dpp v25, v25, v25 row_ror:4 row_mask:0xf bank_mask:0xf
  v_add_f32_dpp v24, v24, v24 row_ror:8 row_mask:0xf bank_mask:0xf
  s_nop 0
  v_add_f32_dpp v25, v25, v25 row_ror:8 row_mask:0xf bank_mask:0xf
  v_add_f32_dpp v24, v24, v24 row_bcast:15 row_mask:0xa bank_mask:0xf
  s_nop 0
  v_add_f32_dpp v25, v25, v25 row_bcast:15 row_mask:0xa bank_mask:0xf
  v_add_f32_dpp v24, v24, v24 row_bcast:31 row_mask:0xc bank_mask:0xf
  s_nop 0
  v_add_f32_dpp v25, v25, v25 row_bcast:31 row_mask:0xc bank_mask:0xf
  v_readlane_b32 s61, v24, 63
  v_readlane_b32 s65, v25, 63
  v_mov_b32 v26, 0x3b000000
  v_mul_f32 v24, s61, v26
  v_mul_f32 v25, s65, v26
  v_fma_f32 v25, -v24, v24, v25
  v_add_f32 v24, s60, v24
  v_max_f32 v25, 0, v25
  v_cvt_pk_bf16_f32 v26, v24, v25
  v_lshlrev_b32 v24, 16, v26
  v_and_b32 v25, 0xffff0000, v26
  v_add_f32 v25, 0x3727c5ac, v25
  v_pk_add_f32 v[8:9], v[8:9], v[24:25] op_sel_hi:[1,0] neg_lo:[0,1] neg_hi:[0,1]
  v_pk_add_f32 v[10:11], v[10:11], v[24:25] op_sel_hi:[1,0] neg_lo:[0,1] neg_hi:[0,1]
  v_cvt_pk_bf16_f32 v26, v25, v25
  v_pk_add_f32 v[12:13], v[12:13], v[24:25] op_sel_hi:[1,0] neg_lo:[0,1] neg_hi:[0,1]
  v_pk_add_f32 v[14:15], v[14:15], v[24:25] op_sel_hi:[1,0] neg_lo:[0,1] neg_hi:[0,1]
  v_and_b32 v25, 0xffff0000, v26
  v_sqrt_f32 v25, v25
  v_cvt_pk_bf16_f32 v16, v8, v9
  v_cvt_pk_bf16_f32 v17, v10, v11
  v_cvt_pk_bf16_f32 v18, v12, v13
  v_cvt_pk_bf16_f32 v19, v14, v15
  v_cvt_pk_bf16_f32 v26, v25, v25
  v_and_b32 v25, 0xffff0000, v26
  v_rcp_f32 v26, v25
  v_lshlrev_b32 v8, 16, v16
  v_and_b32 v9, 0xffff0000, v16
  v_lshlrev_b32 v10, 16, v17
  v_and_b32 v11, 0xffff0000, v17
  v_lshlrev_b32 v12, 16, v18
  v_and_b32 v13, 0xffff0000, v18
  v_lshlrev_b32 v14, 16, v19
  v_and_b32 v15, 0xffff0000, v19
  v_pk_mul_f32 v[8:9], v[8:9], v[26:27] op_sel_hi:[1,0]
  v_pk_mul_f32 v[10:11], v[10:11], v[26:27] op_sel_hi:[1,0]
  v_pk_mul_f32 v[12:13], v[12:13], v[26:27] op_sel_hi:[1,0]
  v_pk_mul_f32 v[14:15], v[14:15], v[26:27] op_sel_hi:[1,0]
  v_cvt_pk_bf16_f32 v16, v8, v9
  v_cvt_pk_bf16_f32 v17, v10, v11
  v_cvt_pk_bf16_f32 v18, v12, v13
  v_cvt_pk_bf16_f32 v19, v14, v15
  v_lshlrev_b32 v8, 16, v16
  v_and_b32 v9, 0xffff0000, v16
  v_lshlrev_b32 v10, 16, v17
  v_and_b32 v11, 0xffff0000, v17
  v_lshlrev_b32 v12, 16, v18
  v_and_b32 v13, 0xffff0000, v18
  v_lshlrev_b32 v14, 16, v19
  v_and_b32 v15, 0xffff0000, v19
  v_pk_mul_f32 v[8:9], v[8:9], v[112:113]
  v_pk_mul_f32 v[10:11], v[10:11], v[114:115]
  v_pk_mul_f32 v[12:13], v[12:13], v[116:117]
  v_pk_mul_f32 v[14:15], v[14:15], v[118:119]
  v_cvt_pk_bf16_f32 v16, v8, v9
  v_cvt_pk_bf16_f32 v17, v10, v11
  v_cvt_pk_bf16_f32 v18, v12, v13
  v_cvt_pk_bf16_f32 v19, v14, v15
  v_lshlrev_b32 v8, 16, v16
  v_and_b32 v9, 0xffff0000, v16
  v_lshlrev_b32 v10, 16, v17
  v_and_b32 v11, 0xffff0000, v17
  v_lshlrev_b32 v12, 16, v18
  v_and_b32 v13, 0xffff0000, v18
  v_lshlrev_b32 v14, 16, v19
  v_and_b32 v15, 0xffff0000, v19
  v_pk_add_f32 v[8:9], v[8:9], v[104:105]
  v_pk_add_f32 v[10:11], v[10:11], v[106:107]
  v_pk_add_f32 v[12:13], v[12:13], v[108:109]
  v_pk_add_f32 v[14:15], v[14:15], v[110:111]
  v_cvt_pk_bf16_f32 v24, v8, v9
  v_cvt_pk_bf16_f32 v25, v10, v11
  v_cvt_pk_bf16_f32 v26, v12, v13
  v_cvt_pk_bf16_f32 v27, v14, v15
  ds_write_b128 v4, v[24:27] offset:18944
  ds_write_b128 v4, v[28:31] offset:20992
  s_waitcnt lgkmcnt(0)
  s_cbranch_execz L_dry_red
  s_barrier
  s_cmp_eq_u32 s67, 0
  s_cbranch_scc1 L_reducer
  s_cmp_ge_u32 s38, 32
  s_cbranch_scc1 L_exit
  s_lshr_b32 s60, s38, 2
  s_lshl_b32 s60, s60, 7
  s_and_b32 s61, s38, 3
  s_lshl_b32 s61, s61, 1
  s_add_u32 s60, s60, s61
  v_lshl_add_u32 v4, v3, 3, s60
  ds_read_u16 v8, v4 offset:20992
  ds_read_u16 v9, v4 offset:9728
  ds_read_u16 v12, v4 offset:22016
  ds_read_u16 v13, v4 offset:14848
  s_lshl_b32 s60, s36, 5
  s_add_u32 s60, s60, s38
  s_mul_i32 s60, s60, 11264
  s_add_u32 s60, s60, 273152
  v_lshl_add_u32 v5, v3, 4, s60
  s_xor_b32 s45, s44, 0x5bd1e995
  v_mov_b32 v10, s44
  v_mov_b32 v11, s45
  s_mov_b64 exec, 0xffff
  s_waitcnt lgkmcnt(0)
  v_lshl_or_b32 v8, v12, 16, v8
  v_lshl_or_b32 v9, v13, 16, v9
  global_store_dwordx4 v5, v[8:11], s[30:31] sc1
L_h1bar:
  s_barrier
  s_barrier
  s_branch L_exit2
L_recv:
  s_lshl_b32 s41, s35, 3
  s_add_u32 s41, s41, s33
  s_lshl_b32 s41, s41, 1
  s_add_u32 s41, s41, s67
  s_mul_i32 s46, s41, 11264
  s_add_u32 s46, s46, 262144
  s_add_u32 s47, s46, 11016
  s_add_u32 s60, s46, 4096
  v_add_u32 v5, s60, v1
  v_add_u32 v7, 4096, v5
  s_lshr_b32 s60, s41, 5
  s_lshl_b32 s60, s60, 11
  s_bfe_u32 s61, s41, 0x30002
  s_lshl_b32 s61, s61, 7
  s_add_u32 s60, s60, s61
  s_and_b32 s61, s41, 3
  s_lshl_b32 s61, s61, 1
  s_add_u32 s60, s60, s61
  v_and_b32 v4, 1, v2
  v_lshl_add_u32 v6, v3, 3, s60
  v_lshl_add_u32 v6, v4, 10, v6
  v_lshlrev_b32 v4, 4, v4
  v_sub_u32 v4, 16, v4
  s_xor_b32 s45, s44, 0x5bd1e995
L_pollX_131:
  s_load_dword s60, s[30:31], s47 glc
  s_waitcnt lgkmcnt(0)
  s_cmp_eq_u32 s60, s44
  s_cbranch_scc1 L_gotX_132
  s_add_u32 s64, s64, 1
  s_cmp_gt_u32 s64, 200000
  s_cbranch_scc1 L_exit
  s_sleep 8
  s_branch L_pollX_131
L_gotX_132:
  s_sleep 14
L_pollI_133:
  global_load_dwordx4 v[44:47], v5, s[30:31] offset:-4096 sc1
  global_load_dwordx4 v[48:51], v5, s[30:31] offset:-3072 sc1
  global_load_dwordx4 v[52:55], v5, s[30:31] offset:-2048 sc1
  global_load_dwordx4 v[56:59], v5, s[30:31] offset:-1024 sc1
  global_load_dwordx4 v[60:63], v5, s[30:31] offset:0 sc1
  global_load_dwordx4 v[64:67], v5, s[30:31] offset:1024 sc1
  global_load_dwordx4 v[68:71], v5, s[30:31] offset:2048 sc1
  global_load_dwordx4 v[72:75], v5, s[30:31] offset:3072 sc1
  global_load_dwordx4 v[76:79], v7, s[30:31] offset:0 sc1
  global_load_dwordx4 v[80:83], v7, s[30:31] offset:1024 sc1
  global_load_dwordx4 v[84:87], v7, s[30:31] offset:2048 sc1
L_dry_r:
  s_waitcnt vmcnt(10)
  v_xor_b32 v10, s44, v46
  v_xor_b32 v11, s45, v47
  v_mov_b32 v8, v44
  v_mov_b32 v9, v45
  s_waitcnt vmcnt(9)
  v_bitop3_b32 v10, v10, v50, s44 bitop3:0xf6
  v_bitop3_b32 v11, v11, v51, s45 bitop3:0xf6
  v_add_f32 v8, v8, v48
  v_add_f32 v9, v9, v49
  s_waitcnt vmcnt(8)
  v_bitop3_b32 v10, v10, v54, s44 bitop3:0xf6
  v_bitop3_b32 v11, v11, v55, s45 bitop3:0xf6
  v_add_f32 v8, v8, v52
  v_add_f32 v9, v9, v53
  s_waitcnt vmcnt(7)
  v_bitop3_b32 v10, v10, v58, s44 bitop3:0xf6
  v_bitop3_b32 v11, v11, v59, s45 bitop3:0xf6
  v_add_f32 v8, v8, v56
  v_add_f32 v9, v9, v57
  s_waitcnt vmcnt(6)
  v_bitop3_b32 v10, v10, v62, s44 bitop3:0xf6
  v_bitop3_b32 v11, v11, v63, s45 bitop3:0xf6
  v_add_f32 v8, v8, v60
  v_add_f32 v9, v9, v61
  s_waitcnt vmcnt(5)
  v_bitop3_b32 v10, v10, v66, s44 bitop3:0xf6
  v_bitop3_b32 v11, v11, v67, s45 bitop3:0xf6
  v_add_f32 v8, v8, v64
  v_add_f32 v9, v9, v65
  s_waitcnt vmcnt(4)
  v_bitop3_b32 v10, v10, v70, s44 bitop3:0xf6
  v_bitop3_b32 v11, v11, v71, s45 bitop3:0xf6
  v_add_f32 v8, v8, v68
  v_add_f32 v9, v9, v69
  s_waitcnt vmcnt(3)
  v_bitop3_b32 v10, v10, v74, s44 bitop3:0xf6
  v_bitop3_b32 v11, v11, v75, s45 bitop3:0xf6
  v_add_f32 v8, v8, v72
  v_add_f32 v9, v9, v73
  s_waitcnt vmcnt(2)
  v_bitop3_b32 v10, v10, v78, s44 bitop3:0xf6
  v_bitop3_b32 v11, v11, v79, s45 bitop3:0xf6
  v_add_f32 v8, v8, v76
  v_add_f32 v9, v9, v77
  s_waitcnt vmcnt(1)
  v_bitop3_b32 v10, v10, v82, s44 bitop3:0xf6
  v_bitop3_b32 v11, v11, v83, s45 bitop3:0xf6
  v_add_f32 v8, v8, v80
  v_add_f32 v9, v9, v81
  s_waitcnt vmcnt(0)
  v_bitop3_b32 v10, v10, v86, s44 bitop3:0xf6
  v_bitop3_b32 v11, v11, v87, s45 bitop3:0xf6
  v_add_f32_dpp v8, v84, v8 quad_perm:[0,1,2,3] row_mask:0x7 bank_mask:0xf
  v_add_f32_dpp v9, v85, v9 quad_perm:[0,1,2,3] row_mask:0x7 bank_mask:0xf
  v_or_b32 v10, v10, v11
  v_cmp_ne_u32 vcc, 0, v10
  s_cbranch_vccz L_gotI_134
  s_add_u32 s64, s64, 1
  s_cmp_gt_u32 s64, 200000
  s_cbranch_scc1 L_exit
  s_branch L_pollI_133
L_gotI_134:
  v_mov_b32 v12, v84
  v_mov_b32 v13, v85
  v_permlane16_swap_b32 v8, v9
  v_permlane32_swap_b32 v12, v84
  v_permlane32_swap_b32 v13, v85
  v_add_f32 v8, v8, v9
  v_mov_b32 v12, v84
  v_mov_b32 v13, v85
  v_mov_b32 v9, v8
  v_permlane16_swap_b32 v12, v84
  v_permlane16_swap_b32 v13, v85
  v_permlane32_swap_b32 v9, v8
  v_lshlrev_b32 v84, v4, v84
  v_lshlrev_b32 v85, v4, v85
  v_add_f32 v8, v8, v9
  v_and_b32 v84, 0xffff0000, v84
  v_and_b32 v85, 0xffff0000, v85
  v_cvt_pk_bf16_f32 v9, v8, v8
  v_and_b32 v8, 0xffff0000, v9
  v_mul_f32 v8, v85, v8
  v_cvt_pk_bf16_f32 v9, v8, v8
  v_and_b32 v8, 0xffff0000, v9
  v_add_f32 v8, v84, v8
  v_cvt_pk_bf16_f32 v8, v8, v8
  s_cbranch_execz L_exit
  s_mov_b32 exec_hi, 0
  global_store_short v6, v8, s[26:27] sc1
  s_mov_b64 exec, -1
  s_branch L_exit
L_reducer:
  v_lshlrev_b32 v4, 2, v0
  v_add_u32 v4, 23040, v4
  v_and_b32 v5, 1, v0
  v_lshlrev_b32 v5, 6, v5
  v_and_b32 v6, 62, v0
  v_add_u32 v5, v5, v6
  s_barrier
L_dry_red:
  ds_read2st64_b32 v[8:9], v4 offset0:0 offset1:1
  ds_read2st64_b32 v[10:11], v4 offset0:2 offset1:3
  ds_read2st64_b32 v[12:13], v4 offset0:4 offset1:5
  ds_read2st64_b32 v[14:15], v4 offset0:6 offset1:7
  ds_read2st64_b32 v[16:17], v4 offset0:8 offset1:9
  ds_read2st64_b32 v[18:19], v4 offset0:10 offset1:11
  ds_read2st64_b32 v[20:21], v4 offset0:12 offset1:13
  ds_read2st64_b32 v[22:23], v4 offset0:14 offset1:15
  s_waitcnt lgkmcnt(4)
  v_add_f32 v8, v8, v10
  v_add_f32 v9, v9, v11
  v_add_f32 v12, v12, v14
  v_add_f32 v13, v13, v15
  v_add_f32 v8, v8, v12
  v_add_f32 v9, v9, v13
  s_waitcnt lgkmcnt(0)
  v_add_f32 v16, v16, v18
  v_add_f32 v17, v17, v19
  v_add_f32 v20, v20, v22
  v_add_f32 v21, v21, v23
  v_add_f32 v16, v16, v20
  v_add_f32 v17, v17, v21
  v_add_f32 v8, v8, v16
  v_add_f32 v9, v9, v17
  v_cvt_pk_bf16_f32 v10, v8, v9
  v_lshlrev_b32 v8, 16, v10
  v_and_b32 v9, 0xffff0000, v10
  v_max_f32 v8, 0xc2ae0000, v8
  v_mul_f32 v11, s66, v8
  v_fma_f32 v12, v8, s66, -v11
  v_exp_f32 v11, -v11
  v_fmac_f32 v12, 0x32a57060, v8
  v_mul_f32 v12, 0xbf317218, v12
  v_fmac_f32 v11, v11, v12
  v_add_f32 v11, 1.0, v11
  v_rcp_f32 v12, v11
  s_nop 0
  v_fma_f32 v13, -v11, v12, 1.0
  v_fmac_f32 v12, v13, v12
  v_fma_f32 v13, -v11, v12, 1.0
  v_fma_f32 v8, v13, v12, v12
  v_cvt_pk_bf16_f32 v10, v8, v8
  v_and_b32 v8, 0xffff0000, v10
  v_mul_f32 v8, v8, v9
  v_cvt_pk_bf16_f32 v8, v8, v8
  ds_write_b16 v5, v8 offset:27136
  s_waitcnt lgkmcnt(0)
  s_cbranch_execz L_dry_s
  s_barrier
  s_branch L_exit2
L_exit2:
L_exit:
L_end:
  s_endpgm
  .fill 64, 4, 0xbf800000
.section .rodata,"a"
.p2align 6
.amdhsa_kernel adaLN_cond__sliding_block_cached__glu_gated_glu__decode_kernel
  .amdhsa_next_free_vgpr 168
  .amdhsa_next_free_sgpr 102
  .amdhsa_accum_offset 168
  .amdhsa_group_segment_fixed_size 0
  .amdhsa_kernarg_size 112
  .amdhsa_user_sgpr_count 2
  .amdhsa_user_sgpr_kernarg_segment_ptr 1
  .amdhsa_system_sgpr_workgroup_id_x 1
  .amdhsa_float_denorm_mode_32 3
.end_amdhsa_kernel
```
